```python
import torch

def _softmax(x, axis=-1):
    return torch.softmax(x, dim=axis)
def _gelu(x):
    return torch.nn.functional.gelu(x, approximate="tanh")
def _silu(x):
    return torch.nn.functional.silu(x)
def _sigmoid(x):
    return torch.sigmoid(x)
def _layernorm(x, axis=-1, eps=1e-5):
    m = x.mean(dim=axis, keepdim=True)
    v = x.var(dim=axis, keepdim=True, unbiased=False)
    return (x - m) / torch.sqrt(v + eps)
def _scatter_add(tgt, idx, src, axis=0):
    return tgt.clone().index_add_(axis, idx, src)
def _segment_sum(src, seg, n):
    out = torch.zeros((n,) + src.shape[1:], dtype=src.dtype)
    return out.index_add_(0, seg, src)
def _pad(x, pw):
    flat = tuple(v for pair in reversed(pw) for v in pair)
    return torch.nn.functional.pad(x, flat)

kernel_name = 'recurrent_scan__sliding_block_cached__geglu_ffn__decode'

def setup_inputs():

    _w = (lambda a: (lambda t: t.to(torch.bfloat16) if t.is_floating_point() else t)(torch.as_tensor(a)))
    def _A_setup():
        B, Sq, D = 4, 1, 576
        Hq, Hkv, Sk, Dh = 32, 16, 8192, 128
        assert Hq % Hkv == 0, (Hq, Hkv)
        return {
            "x": _w((lambda *s: torch.randn(*s, dtype=torch.bfloat16) * 0.05)(B, Sq, D)),
            "k_cache": _w((lambda *s: torch.randn(*s, dtype=torch.bfloat16) * 0.8)(B, Hkv, Sk, Dh)),
            "v_cache": _w((lambda *s: torch.randn(*s, dtype=torch.bfloat16) * 0.2)(B, Hkv, Sk, Dh)),
            "wq": _w((lambda *s: torch.randn(*s, dtype=torch.bfloat16) * 0.8)(D, Hq * Dh) * (D ** -0.5)),
            "wo": _w((lambda *s: torch.randn(*s, dtype=torch.bfloat16) * 0.2)(Hq * Dh, D) * ((Hq * Dh) ** -0.5)),
        }
    _A_in = _A_setup()

    def _B_setup():
        B, S, D, F = 4, 1, 576, 4608
        return {
            "x": _w((lambda *s: torch.randn(*s, dtype=torch.bfloat16) * 0.05)(B, S, D)),
            "w_gate": _w((lambda *s: torch.randn(*s, dtype=torch.bfloat16) * 0.1)(D, F)),
            "w_up": _w((lambda *s: torch.randn(*s, dtype=torch.bfloat16) * 0.1)(D, F)),
            "w_down": _w((lambda *s: torch.randn(*s, dtype=torch.bfloat16) * 0.1)(F, D)),
        }
    _B_in = _B_setup()

    return {
        "A_x": _A_in["x"],
        "A_k_cache": _A_in["k_cache"],
        "A_v_cache": _A_in["v_cache"],
        "A_wq": _A_in["wq"],
        "A_wo": _A_in["wo"],
        "B_x": _B_in["x"],
        "B_w_gate": _B_in["w_gate"],
        "B_w_up": _B_in["w_up"],
        "B_w_down": _B_in["w_down"],
    }

def reference(A_x, A_k_cache, A_v_cache, A_wq, A_wo, B_x, B_w_gate, B_w_up, B_w_down):
    def _A_ref(x, k_cache, v_cache, wq, wo):
        B, Sq, D = x.shape
        Hq, Dh = 32, 128
        Hkv, Sk = k_cache.shape[1], k_cache.shape[2]
        W = min(4096, max(256, Sk // 4))
        rep = Hq // Hkv
        q = (lambda x, *d: x.permute(*d))((x @ wq).reshape(B, Sq, Hq, Dh), 0, 2, 1, 3)
        k = (lambda x, n, axis: torch.repeat_interleave(x, n, dim=axis))(k_cache[:, :, Sk - W:, :], rep, axis=1)
        v = (lambda x, n, axis: torch.repeat_interleave(x, n, dim=axis))(v_cache[:, :, Sk - W:, :], rep, axis=1)
        scores = torch.einsum("bhqd,bhkd->bhqk", q, k) * (Dh ** -0.5)
        p = _softmax(scores, axis=-1)
        o = torch.einsum("bhqk,bhkd->bhqd", p, v)
        return (lambda x, *d: x.permute(*d))(o, 0, 2, 1, 3).reshape(B, Sq, Hq * Dh) @ wo

    def _B_ref(x, w_gate, w_up, w_down):
        return (_gelu(x @ w_gate) * (x @ w_up)) @ w_down

    x = A_x
    xn = _layernorm(x, axis=-1)
    s = _A_ref(xn, A_k_cache, A_v_cache, A_wq, A_wo)
    g = _silu(_B_ref(xn, B_w_gate, B_w_up, B_w_down))
    return x + s * g
```

```asm
; @launch grid=(256,1,1) block=(384,1,1) lds=163584
.amdgcn_target "amdgcn-amd-amdhsa--gfx950"
.text
.globl recurrent_scan__sliding_block_cached__geglu_ffn__decode_kernel
.p2align 8
.type recurrent_scan__sliding_block_cached__geglu_ffn__decode_kernel,@function
recurrent_scan__sliding_block_cached__geglu_ffn__decode_kernel:
    s_cmp_ge_u32 s2, 256
    s_cbranch_scc1 L_end
    s_load_dwordx16 s[4:19], s[0:1], 0
    s_load_dwordx8 s[20:27], s[0:1], 64
    v_lshrrev_b32 v1, 6, v0
    v_and_b32 v0, 63, v0
    s_and_b32 s30, s2, 7
    s_mov_b32 s69, 0x400000
    v_readfirstlane_b32 s36, v1
    s_lshr_b32 s31, s2, 3
    s_lshr_b32 s32, s31, 4
    s_lshl_b32 s33, s30, 1
    s_add_u32 s32, s32, s33
    s_lshr_b32 s34, s31, 2
    s_and_b32 s34, s34, 3
    s_and_b32 s35, s31, 3
    s_lshl_b32 s33, s34, 4
    s_add_u32 s33, s33, s32
    s_cmp_eq_u32 s36, 1
    s_cbranch_scc1 L_comm
    s_cmp_lg_u32 s36, 0
    s_cbranch_scc1 L_cons
    s_setprio 3
    s_memrealtime s[28:29]
    v_lshrrev_b32 v12, 3, v0
    v_and_b32 v13, 7, v0
    v_and_b32 v14, 6, v12
    v_xor_b32 v13, v13, v14
    v_lshlrev_b32 v13, 4, v13
    s_lshl_b32 s46, s33, 21
    s_lshl_b32 s47, s35, 17
    s_add_u32 s46, s46, s47
    s_add_u32 s46, s46, 0x180000
    s_mov_b32 s63, 0x00020000
    s_cmp_lt_u32 s31, 26
    s_cbranch_scc1 L_ld_cfirst
    v_lshrrev_b32 v8, 4, v0
    v_and_b32 v9, 15, v0
    v_lshlrev_b32 v10, 1, v8
    v_xor_b32 v11, v9, v10
    v_lshlrev_b32 v11, 4, v11
    v_lshl_add_u32 v3, v8, 8, v11
    v_xor_b32 v4, 0x80, v3
    v_mov_b32 v5, v3
    v_mov_b32 v6, v4
    s_movk_i32 s41, 4096
    s_mov_b32 s51, s46
    s_mov_b32 s43, 0
    s_mov_b32 s62, 0x8000000
    s_mov_b32 m0, 0x12000
    s_waitcnt lgkmcnt(0)
    s_mov_b32 s60, s6
    s_mov_b32 s61, s7
    s_branch L_ld_pre
L_ld_cfirst:
    s_mul_i32 s43, s30, 9
    s_add_u32 s43, s43, s31
    s_cmp_lt_u32 s31, 17
    s_cselect_b32 s44, 8, 17
    s_movk_i32 s40, 0x2400
    s_cmp_lt_u32 s31, 8
    s_cselect_b32 s44, s30, s44
    s_cselect_b32 s40, 0x2000, s40
    s_sub_u32 s43, s43, s44
    s_lshl_b32 s51, s43, 7
    v_mad_u32_u24 v3, v12, s40, v13
    s_lshl_b32 s41, s40, 5
    s_lshl_b32 s42, s40, 3
    s_sub_u32 s42, s42, 1024
    v_add_u32 v4, s42, v3
    v_add_u32 v5, s42, v4
    v_add_u32 v6, s42, v5
    s_mul_i32 s62, s40, 576
    s_mov_b32 m0, 0
    s_cmp_lt_u32 s31, 17
    s_waitcnt lgkmcnt(0)
    s_cselect_b32 s60, s16, s18
    s_cselect_b32 s61, s17, s19
    s_cmp_lt_u32 s31, 8
    s_cselect_b32 s60, s10, s60
    s_cselect_b32 s61, s11, s61
L_ld_pre:
    buffer_load_dwordx4 v3, s[60:63], s51 offen nt lds
    buffer_load_dwordx4 v4, s[60:63], s51 offen offset:1024 nt lds
    buffer_load_dwordx4 v5, s[60:63], s51 offen offset:2048 nt lds
    buffer_load_dwordx4 v6, s[60:63], s51 offen offset:3072 nt lds
    s_add_u32 m0, m0, 4096
    s_add_u32 s51, s51, s41
    buffer_load_dwordx4 v3, s[60:63], s51 offen nt lds
    buffer_load_dwordx4 v4, s[60:63], s51 offen offset:1024 nt lds
    buffer_load_dwordx4 v5, s[60:63], s51 offen offset:2048 nt lds
    buffer_load_dwordx4 v6, s[60:63], s51 offen offset:3072 nt lds
    s_add_u32 m0, m0, 4096
    s_add_u32 s51, s51, s41
    buffer_load_dwordx4 v3, s[60:63], s51 offen nt lds
    buffer_load_dwordx4 v4, s[60:63], s51 offen offset:1024 nt lds
    buffer_load_dwordx4 v5, s[60:63], s51 offen offset:2048 nt lds
    buffer_load_dwordx4 v6, s[60:63], s51 offen offset:3072 nt lds
    s_add_u32 m0, m0, 4096
    s_add_u32 s51, s51, s41
    buffer_load_dwordx4 v3, s[60:63], s51 offen nt lds
    buffer_load_dwordx4 v4, s[60:63], s51 offen offset:1024 nt lds
    buffer_load_dwordx4 v5, s[60:63], s51 offen offset:2048 nt lds
    buffer_load_dwordx4 v6, s[60:63], s51 offen offset:3072 nt lds
    s_add_u32 m0, m0, 4096
    s_add_u32 s51, s51, s41
    buffer_load_dwordx4 v3, s[60:63], s51 offen nt lds
    buffer_load_dwordx4 v4, s[60:63], s51 offen offset:1024 nt lds
    buffer_load_dwordx4 v5, s[60:63], s51 offen offset:2048 nt lds
    buffer_load_dwordx4 v6, s[60:63], s51 offen offset:3072 nt lds
    s_add_u32 m0, m0, 4096
    s_add_u32 s51, s51, s41
    buffer_load_dwordx4 v3, s[60:63], s51 offen nt lds
    buffer_load_dwordx4 v4, s[60:63], s51 offen offset:1024 nt lds
    buffer_load_dwordx4 v5, s[60:63], s51 offen offset:2048 nt lds
    buffer_load_dwordx4 v6, s[60:63], s51 offen offset:3072 nt lds
    s_add_u32 s51, s51, s41
    v_lshrrev_b32 v8, 4, v0
    v_and_b32 v9, 15, v0
    v_lshlrev_b32 v10, 1, v8
    v_xor_b32 v11, v9, v10
    v_lshlrev_b32 v11, 4, v11
    v_lshl_add_u32 v1, v8, 8, v11
    v_xor_b32 v2, 0x80, v1
    v_mul_u32_u24 v20, 1152, v12
    v_add_u32 v20, v20, v13
    v_add_u32 v21, 8192, v20
    v_add_u32 v22, 8192, v21
    v_add_u32 v23, 8192, v22
    v_add_u32 v12, 0, v0
    v_mul_u32_u24 v13, 2731, v12
    v_lshrrev_b32 v13, 16, v13
    v_mul_u32_u24 v14, 24, v13
    v_sub_u32 v14, v12, v14
    v_and_b32 v15, 6, v13
    v_xor_b32 v14, v14, v15
    v_mul_u32_u24 v13, 1152, v13
    v_lshl_add_u32 v17, v14, 4, v13
    v_add_u32 v12, 64, v0
    v_mul_u32_u24 v13, 2731, v12
    v_lshrrev_b32 v13, 16, v13
    v_mul_u32_u24 v14, 24, v13
    v_sub_u32 v14, v12, v14
    v_and_b32 v15, 6, v13
    v_xor_b32 v14, v14, v15
    v_mul_u32_u24 v13, 1152, v13
    v_lshl_add_u32 v18, v14, 4, v13
    v_add_u32 v12, 128, v0
    v_mul_u32_u24 v13, 2731, v12
    v_lshrrev_b32 v13, 16, v13
    v_mul_u32_u24 v14, 24, v13
    v_sub_u32 v14, v12, v14
    v_and_b32 v15, 6, v13
    v_xor_b32 v14, v14, v15
    v_mul_u32_u24 v13, 1152, v13
    v_lshl_add_u32 v19, v14, 4, v13
    v_mov_b32 v7, v17
    v_add_u32 v8, 0xfffffc00, v18
    v_add_u32 v9, 0xfffff800, v19
    v_lshlrev_b32 v10, 2, v0
    v_add_u32 v10, 161024, v10
    v_mov_b32 v11, 161280
    v_mov_b32 v18, 161424
    s_mov_b32 s55, 0
    s_sub_u32 s38, s31, 8
    s_cmp_ge_u32 s38, 9
    s_cselect_b32 s37, 1, 0
    s_cselect_b32 s39, 9, 0
    s_sub_u32 s38, s38, s39
    s_cmp_ge_u32 s31, 26
    s_cbranch_scc0 Lt_1
    s_sub_u32 s38, s31, 26
    s_cmp_ge_u32 s38, 3
    s_cselect_b32 s37, 17, 16
    s_cselect_b32 s39, 3, 0
    s_sub_u32 s38, s38, s39
Lt_1:
    s_lshl_b32 s39, s30, 1
    s_add_u32 s37, s37, s39
    s_mov_b32 s57, 20
    s_cmp_lt_u32 s31, 8
    s_cselect_b32 s57, 20, s57
    s_and_b32 s54, s43, 7
    s_cmp_eq_u32 s54, 3
    s_cselect_b32 s57, 24, s57
    s_cmp_ge_u32 s31, 26
    s_cselect_b32 s57, 20, s57
    s_cselect_b32 s58, 72, 0
    s_cselect_b32 s54, 0, 0
    s_mov_b32 s59, s57
    s_cmp_lt_u32 s31, 8
    s_cselect_b32 s54, 0, s54
    s_add_u32 s28, s28, s54
    s_barrier
    s_cmp_ge_u32 s31, 26
    s_cbranch_scc1 L_ld_nocol
    s_mov_b32 s50, 24576
    s_mov_b32 s53, 24
    s_mov_b32 s56, 32
    s_mov_b32 s52, 12
Lrun_2:
    s_mov_b32 m0, s50
    s_add_u32 s50, s50, 4096
    buffer_load_dwordx4 v3, s[60:63], s51 offen nt lds
    buffer_load_dwordx4 v4, s[60:63], s51 offen offset:1024 nt lds
    buffer_load_dwordx4 v5, s[60:63], s51 offen offset:2048 nt lds
    buffer_load_dwordx4 v6, s[60:63], s51 offen offset:3072 nt lds
    s_add_u32 s51, s51, s41
    s_cmp_eq_u32 s50, 151552
    s_cselect_b32 s50, 0, s50
    s_add_u32 s53, s53, 4
    s_waitcnt vmcnt(32)
    s_cmp_ge_u32 s57, 32
    s_cbranch_scc1 Lwd_3
    s_waitcnt vmcnt(28)
    s_cmp_ge_u32 s57, 28
    s_cbranch_scc1 Lwd_3
    s_waitcnt vmcnt(24)
    s_cmp_ge_u32 s57, 24
    s_cbranch_scc1 Lwd_3
    s_waitcnt vmcnt(20)
Lwd_3:
    s_sub_u32 s54, s53, s57
    v_mov_b32 v16, s54
    ds_write_b32 v10, v16
    s_sub_u32 s52, s52, 1
    s_cmp_lg_u32 s52, 0
    s_cbranch_scc1 Lrun_2
    s_branch L_ld_k
L_ld_nocol:
    s_mov_b32 s46, s51
    s_mov_b32 s50, 98304
    s_mov_b32 s53, 96
    s_mov_b32 s56, 26
L_ld_k:
    s_mov_b32 s60, s6
    s_mov_b32 s61, s7
    s_mov_b32 s62, 0x8000000
    s_mov_b32 s51, s46
    s_sub_u32 s52, s56, 24
    s_mov_b32 s56, 8
L_ld_seg:
    s_memrealtime s[64:65]
    s_sub_u32 s54, s53, s58
    s_mul_i32 s54, s54, 883
    s_lshr_b32 s54, s54, 8
    s_waitcnt lgkmcnt(0)
    s_sub_u32 s64, s64, s28
    s_sub_u32 s64, s64, s54
    s_mov_b32 s57, s59
    s_add_u32 s54, s59, 4
    s_cmp_ge_i32 s64, 50
    s_cselect_b32 s57, s54, s57
    s_add_u32 s54, s59, 8
    s_cmp_ge_i32 s64, 70
    s_cselect_b32 s57, s54, s57
    s_add_u32 s54, s59, 12
    s_cmp_ge_i32 s64, 90
    s_cselect_b32 s57, s54, s57
    s_min_u32 s57, s57, 32
Lrun_4:
    s_add_i32 s54, s53, -144
    s_cmp_le_i32 s54, s55
    s_cbranch_scc1 Lok_5
Lsl_6:
    ds_read_b128 v[12:15], v11
    s_waitcnt lgkmcnt(0)
    v_min_u32 v12, v12, v13
    v_min3_u32 v12, v12, v14, v15
    s_nop 0
    v_readfirstlane_b32 s55, v12
    s_cmp_le_i32 s54, s55
    s_cbranch_scc1 Lok_5
    s_sub_i32 s69, s69, 1
    s_cmp_gt_i32 s69, 0
    s_cbranch_scc1 Lsl_6
Lok_5:
    s_mov_b32 m0, s50
    s_add_u32 s50, s50, 4096
    buffer_load_dwordx4 v1, s[60:63], s51 offen nt lds
    buffer_load_dwordx4 v2, s[60:63], s51 offen offset:1024 nt lds
    buffer_load_dwordx4 v1, s[60:63], s51 offen offset:2048 nt lds
    buffer_load_dwordx4 v2, s[60:63], s51 offen offset:3072 nt lds
    s_add_u32 s51, s51, 4096
    s_cmp_eq_u32 s50, 151552
    s_cselect_b32 s50, 0, s50
    s_add_u32 s53, s53, 4
    s_waitcnt vmcnt(32)
    s_cmp_ge_u32 s57, 32
    s_cbranch_scc1 Lwd_7
    s_waitcnt vmcnt(28)
    s_cmp_ge_u32 s57, 28
    s_cbranch_scc1 Lwd_7
    s_waitcnt vmcnt(24)
    s_cmp_ge_u32 s57, 24
    s_cbranch_scc1 Lwd_7
    s_waitcnt vmcnt(20)
Lwd_7:
    s_sub_u32 s54, s53, s57
    v_mov_b32 v16, s54
    ds_write_b32 v10, v16
    s_sub_u32 s52, s52, 1
    s_cmp_lg_u32 s52, 0
    s_cbranch_scc1 Lrun_4
    s_cmp_lg_u32 s56, 5
    s_cbranch_scc1 L_ld_seg2
    s_mov_b32 s60, s8
    s_mov_b32 s61, s9
    s_sub_u32 s51, s51, 0x20000
L_ld_seg2:
    s_mov_b32 s52, 8
    s_sub_u32 s56, s56, 1
    s_cmp_lg_u32 s56, 0
    s_cbranch_scc1 L_ld_seg
    s_memrealtime s[64:65]
    s_sub_u32 s54, s53, s58
    s_mul_i32 s54, s54, 883
    s_lshr_b32 s54, s54, 8
    s_waitcnt lgkmcnt(0)
    s_sub_u32 s64, s64, s28
    s_sub_u32 s64, s64, s54
    s_mov_b32 s57, s59
    s_add_u32 s54, s59, 4
    s_cmp_ge_i32 s64, 50
    s_cselect_b32 s57, s54, s57
    s_add_u32 s54, s59, 8
    s_cmp_ge_i32 s64, 70
    s_cselect_b32 s57, s54, s57
    s_add_u32 s54, s59, 12
    s_cmp_ge_i32 s64, 90
    s_cselect_b32 s57, s54, s57
    s_min_u32 s57, s57, 32
    s_cmp_ge_u32 s31, 26
    s_cbranch_scc1 L_ld_down
    s_cmp_lt_u32 s31, 8
    s_cbranch_scc1 L_ld_drain
    s_mov_b32 s60, s12
    s_mov_b32 s61, s13
    s_mov_b32 s62, 4718592
    s_mul_i32 s51, s37, 294912
    s_lshl_b32 s54, s38, 7
    s_add_u32 s51, s51, s54
    s_mov_b32 s52, 8
Lrun_8:
    s_add_i32 s54, s53, -144
    s_cmp_le_i32 s54, s55
    s_cbranch_scc1 Lok_9
Lsl_10:
    ds_read_b128 v[12:15], v11
    s_waitcnt lgkmcnt(0)
    v_min_u32 v12, v12, v13
    v_min3_u32 v12, v12, v14, v15
    s_nop 0
    v_readfirstlane_b32 s55, v12
    s_cmp_le_i32 s54, s55
    s_cbranch_scc1 Lok_9
    s_sub_i32 s69, s69, 1
    s_cmp_gt_i32 s69, 0
    s_cbranch_scc1 Lsl_10
Lok_9:
    s_mov_b32 m0, s50
    s_add_u32 s50, s50, 4096
    buffer_load_dwordx4 v20, s[60:63], s51 offen nt lds
    buffer_load_dwordx4 v21, s[60:63], s51 offen offset:1024 nt lds
    buffer_load_dwordx4 v22, s[60:63], s51 offen offset:2048 nt lds
    buffer_load_dwordx4 v23, s[60:63], s51 offen offset:3072 nt lds
    s_add_u32 s51, s51, 36864
    s_cmp_eq_u32 s50, 151552
    s_cselect_b32 s50, 0, s50
    s_add_u32 s53, s53, 4
    s_waitcnt vmcnt(32)
    s_cmp_ge_u32 s57, 32
    s_cbranch_scc1 Lwd_11
    s_waitcnt vmcnt(28)
    s_cmp_ge_u32 s57, 28
    s_cbranch_scc1 Lwd_11
    s_waitcnt vmcnt(24)
    s_cmp_ge_u32 s57, 24
    s_cbranch_scc1 Lwd_11
    s_waitcnt vmcnt(20)
Lwd_11:
    s_sub_u32 s54, s53, s57
    v_mov_b32 v16, s54
    ds_write_b32 v10, v16
    s_sub_u32 s52, s52, 1
    s_cmp_lg_u32 s52, 0
    s_cbranch_scc1 Lrun_8
    s_branch L_ld_drain
L_ld_down:
    s_mov_b32 s60, s20
    s_mov_b32 s61, s21
    s_mov_b32 s62, 5308416
    s_sub_u32 s51, s37, 16
    s_mul_i32 s51, s51, 331776
    s_mul_i32 s54, s38, 384
    s_add_u32 s51, s51, s54
    s_mov_b32 s56, 3
L_ld_dseg:
    s_mov_b32 s52, 12
Lrun_12:
    s_add_i32 s54, s53, -145
    s_cmp_le_i32 s54, s55
    s_cbranch_scc1 Lok_13
Lsl_14:
    ds_read_b128 v[12:15], v11
    s_waitcnt lgkmcnt(0)
    v_min_u32 v12, v12, v13
    v_min3_u32 v12, v12, v14, v15
    s_nop 0
    v_readfirstlane_b32 s55, v12
    s_cmp_le_i32 s54, s55
    s_cbranch_scc1 Lok_13
    s_sub_i32 s69, s69, 1
    s_cmp_gt_i32 s69, 0
    s_cbranch_scc1 Lsl_14
Lok_13:
    s_mov_b32 m0, s50
    s_add_u32 s50, s50, 3072
    buffer_load_dwordx4 v7, s[60:63], s51 offen nt lds
    buffer_load_dwordx4 v8, s[60:63], s51 offen offset:1024 nt lds
    buffer_load_dwordx4 v9, s[60:63], s51 offen offset:2048 nt lds
    s_add_u32 s51, s51, 9216
    s_cmp_eq_u32 s50, 151552
    s_cselect_b32 s50, 0, s50
    s_add_u32 s53, s53, 3
    s_waitcnt vmcnt(32)
    s_cmp_ge_u32 s57, 32
    s_cbranch_scc1 Lwd_15
    s_waitcnt vmcnt(28)
    s_cmp_ge_u32 s57, 28
    s_cbranch_scc1 Lwd_15
    s_waitcnt vmcnt(24)
    s_cmp_ge_u32 s57, 24
    s_cbranch_scc1 Lwd_15
    s_waitcnt vmcnt(20)
Lwd_15:
    s_sub_u32 s54, s53, s57
    v_mov_b32 v16, s54
    ds_write_b32 v10, v16
    s_sub_u32 s52, s52, 1
    s_cmp_lg_u32 s52, 0
    s_cbranch_scc1 Lrun_12
    s_memrealtime s[64:65]
    s_sub_u32 s54, s53, s58
    s_mul_i32 s54, s54, 883
    s_lshr_b32 s54, s54, 8
    s_waitcnt lgkmcnt(0)
    s_sub_u32 s64, s64, s28
    s_sub_u32 s64, s64, s54
    s_mov_b32 s57, s59
    s_add_u32 s54, s59, 4
    s_cmp_ge_i32 s64, 50
    s_cselect_b32 s57, s54, s57
    s_add_u32 s54, s59, 8
    s_cmp_ge_i32 s64, 70
    s_cselect_b32 s57, s54, s57
    s_add_u32 s54, s59, 12
    s_cmp_ge_i32 s64, 90
    s_cselect_b32 s57, s54, s57
    s_min_u32 s57, s57, 32
    s_sub_u32 s56, s56, 1
    s_cmp_lg_u32 s56, 0
    s_cbranch_scc1 L_ld_dseg
L_ld_drain:
    s_waitcnt vmcnt(28)
    s_sub_u32 s54, s53, 28
    v_mov_b32 v16, s54
    ds_write_b32 v10, v16
    s_waitcnt vmcnt(24)
    s_sub_u32 s54, s53, 24
    v_mov_b32 v16, s54
    ds_write_b32 v10, v16
    s_waitcnt vmcnt(20)
    s_sub_u32 s54, s53, 20
    v_mov_b32 v16, s54
    ds_write_b32 v10, v16
    s_waitcnt vmcnt(16)
    s_sub_u32 s54, s53, 16
    v_mov_b32 v16, s54
    ds_write_b32 v10, v16
    s_waitcnt vmcnt(12)
    s_sub_u32 s54, s53, 12
    v_mov_b32 v16, s54
    ds_write_b32 v10, v16
    s_waitcnt vmcnt(8)
    s_sub_u32 s54, s53, 8
    v_mov_b32 v16, s54
    ds_write_b32 v10, v16
    s_waitcnt vmcnt(4)
    s_sub_u32 s54, s53, 4
    v_mov_b32 v16, s54
    ds_write_b32 v10, v16
    s_waitcnt vmcnt(0)
    s_sub_u32 s54, s53, 0
    v_mov_b32 v16, s54
    ds_write_b32 v10, v16
    s_endpgm
L_comm:
    v_lshlrev_b32 v1, 3, v0
    v_add_u32 v1, 161024, v1
    v_mov_b32 v2, 0
    v_mov_b32 v3, 0
    ds_write_b64 v1, v[2:3]
    v_mov_b32 v4, -1
    v_mov_b32 v5, -1
    v_mov_b32 v6, -1
    v_mov_b32 v7, -1
    v_lshlrev_b32 v8, 4, v0
    s_sub_u32 s38, s31, 8
    s_cmp_ge_u32 s38, 9
    s_cselect_b32 s37, 1, 0
    s_cselect_b32 s39, 9, 0
    s_sub_u32 s38, s38, s39
    s_cmp_ge_u32 s31, 26
    s_cbranch_scc0 Lt_16
    s_sub_u32 s38, s31, 26
    s_cmp_ge_u32 s38, 3
    s_cselect_b32 s37, 17, 16
    s_cselect_b32 s39, 3, 0
    s_sub_u32 s38, s38, s39
Lt_16:
    s_lshl_b32 s39, s30, 1
    s_add_u32 s37, s37, s39
    s_lshl_b32 s44, s30, 3
    s_add_u32 s44, s44, s31
    s_mul_i32 s46, s30, 9
    s_add_u32 s46, s46, s31
    s_add_u32 s47, s46, 56
    s_add_u32 s46, s46, 119
    s_cmp_lt_u32 s31, 17
    s_cselect_b32 s46, s47, s46
    s_cmp_lt_u32 s31, 8
    s_cselect_b32 s44, s44, s46
    s_lshl_b32 s45, s33, 2
    s_add_u32 s45, s45, s35
    s_movk_i32 s46, 18432
    s_cmp_lt_u32 s31, 8
    s_cselect_b32 s46, 8192, s46
    s_cselect_b32 s47, 0, 24576
    s_mul_i32 s52, s44, 10112
    s_lshl_b32 s44, s44, 7
    s_add_u32 s44, s44, s47
    v_lshrrev_b32 v9, 3, v0
    v_mul_lo_u32 v9, v9, s46
    v_and_b32 v10, 7, v0
    v_lshl_add_u32 v9, v10, 4, v9
    v_lshlrev_b32 v12, 2, v0
    v_add_u32 v13, 161536, v8
    v_mov_b32 v23, 161416
    s_waitcnt lgkmcnt(0)
    s_barrier
    s_mov_b32 s40, s26
    s_mov_b32 s41, s27
    s_mov_b32 s42, 679936
    s_mov_b32 s43, 0x00020000
    s_mov_b32 s48, s24
    s_mov_b32 s49, s25
    s_mov_b32 s50, 256
    s_mov_b32 s51, 0x00020000
    s_cmp_ge_u32 s31, 8
    s_cbranch_scc1 L_cm_noclr
    s_mov_b32 exec_hi, 0
    buffer_store_dwordx4 v[4:7], v9, s[40:43], s44 offen sc1
    s_mov_b32 exec_hi, -1
    s_add_u32 s52, s52, 32768
    buffer_store_dwordx4 v[4:7], v8, s[40:43], s52 offen offset:0 sc1
    buffer_store_dwordx4 v[4:7], v8, s[40:43], s52 offen offset:1024 sc1
    buffer_store_dwordx4 v[4:7], v8, s[40:43], s52 offen offset:2048 sc1
    buffer_store_dwordx4 v[4:7], v8, s[40:43], s52 offen offset:3072 sc1
    s_add_u32 s52, s52, 4096
    buffer_store_dwordx4 v[4:7], v8, s[40:43], s52 offen offset:0 sc1
    buffer_store_dwordx4 v[4:7], v8, s[40:43], s52 offen offset:1024 sc1
    buffer_store_dwordx4 v[4:7], v8, s[40:43], s52 offen offset:2048 sc1
    buffer_store_dwordx4 v[4:7], v8, s[40:43], s52 offen offset:3072 sc1
    s_add_u32 s52, s52, 4096
    buffer_store_dwordx4 v[4:7], v8, s[40:43], s52 offen offset:0 sc1
    s_mov_b32 exec_hi, 0xffffff
    buffer_store_dwordx4 v[4:7], v8, s[40:43], s52 offen offset:1024 sc1
    s_lshr_b32 s46, s44, 5
    v_mov_b32 v10, 1
    v_mov_b32 v11, 0
    s_mov_b64 exec, 1
    s_waitcnt vmcnt(0)
    buffer_store_dword v10, v11, s[48:51], s46 offen sc1
    s_mov_b64 exec, -1
Lw_17:
    ds_read_b32 v14, v23
    s_waitcnt lgkmcnt(0)
    v_readfirstlane_b32 s46, v14
    s_cmp_ge_i32 s46, 4
    s_cbranch_scc1 Ld_18
    s_sleep 2
    s_sub_i32 s69, s69, 1
    s_cmp_gt_i32 s69, 0
    s_cbranch_scc1 Lw_17
Ld_18:
    s_mov_b32 exec_hi, 0
    ds_read_b128 v[16:19], v13
    s_waitcnt lgkmcnt(0)
    buffer_store_dwordx4 v[16:19], v9, s[40:43], s44 offen sc1
    s_mov_b32 exec_hi, -1
L_cm_noclr:
    s_mov_b32 s47, 88
    s_cmp_ge_u32 s31, 26
    s_cselect_b32 s47, 170, s47
    v_mov_b32 v15, 161024
Lw_19:
    ds_read_b32 v14, v15
    s_waitcnt lgkmcnt(0)
    v_readfirstlane_b32 s46, v14
    s_cmp_ge_i32 s46, s47
    s_cbranch_scc1 Ld_20
    s_sleep 4
    s_sub_i32 s69, s69, 1
    s_cmp_gt_i32 s69, 0
    s_cbranch_scc1 Lw_19
Ld_20:
    s_mov_b32 s59, 65536
    s_mov_b32 s46, 1
Lfl_21:
    buffer_load_dword v14, v12, s[48:51], 0 offen sc1
    s_waitcnt vmcnt(0)
    v_cmp_eq_u32 vcc, 0, v14
    s_cbranch_vccz Lfld_22
    s_sleep 16
    s_sub_u32 s59, s59, 1
    s_cmp_lg_u32 s59, 0
    s_cbranch_scc1 Lfl_21
Lfld_22:
    s_cmp_lt_u32 s31, 8
    s_cbranch_scc1 L_cm_nocs
    s_cmp_ge_u32 s31, 26
    s_cbranch_scc1 L_cm_nocs
Lw_23:
    ds_read_b32 v14, v23
    s_waitcnt lgkmcnt(0)
    v_readfirstlane_b32 s46, v14
    s_cmp_ge_i32 s46, 4
    s_cbranch_scc1 Ld_24
    s_sleep 2
    s_sub_i32 s69, s69, 1
    s_cmp_gt_i32 s69, 0
    s_cbranch_scc1 Lw_23
Ld_24:
    s_mov_b32 exec_hi, 0
    ds_read_b128 v[16:19], v13
    s_waitcnt lgkmcnt(0)
    buffer_store_dwordx4 v[16:19], v9, s[40:43], s44 offen sc1
    s_mov_b32 exec_hi, -1
L_cm_nocs:
    s_add_u32 s47, s47, 32
Lw_25:
    ds_read_b32 v14, v15
    s_waitcnt lgkmcnt(0)
    v_readfirstlane_b32 s46, v14
    s_cmp_ge_i32 s46, s47
    s_cbranch_scc1 Ld_26
    s_sleep 4
    s_sub_i32 s69, s69, 1
    s_cmp_gt_i32 s69, 0
    s_cbranch_scc1 Lw_25
Ld_26:
    s_mul_i32 s46, s34, 8192
    s_lshl_b32 s47, s32, 9
    s_add_u32 s46, s46, s47
    s_mov_b32 exec_hi, 0
    s_mov_b32 s59, 65536
    s_mov_b64 s[90:91], exec
    buffer_load_dwordx4 v[16:19], v8, s[40:43], s46 offen sc1
    s_branch Lgp_29
Lg_27:
    s_mov_b64 exec, vcc
    buffer_load_dwordx4 v[16:19], v8, s[40:43], s46 offen sc1
    s_mov_b64 exec, s[90:91]
Lgp_29:
    s_waitcnt vmcnt(0)
    v_max3_u32 v20, v16, v17, v18
    v_max_u32 v20, v20, v19
    v_cmp_eq_u32 vcc, -1, v20
    s_cbranch_vccz Lgd_28
    s_sleep 8
    s_sub_u32 s59, s59, 1
    s_cmp_lg_u32 s59, 0
    s_cbranch_scc1 Lg_27
Lgd_28:
    v_add_u32 v21, 156416, v8
    ds_write_b128 v21, v[16:19]
    s_waitcnt lgkmcnt(0)
    s_mov_b64 exec, 1
    v_mov_b32 v21, 161400
    v_mov_b32 v22, 1
    ds_write_b32 v21, v22
    s_mov_b64 exec, -1
    s_cmp_lt_u32 s31, 26
    s_cbranch_scc1 L_cm_noh
    v_add_u32 v16, 0, v0
    v_mul_u32_u24 v17, 1821, v16
    v_lshrrev_b32 v17, 16, v17
    v_mul_u32_u24 v18, 36, v17
    v_sub_u32 v18, v16, v18
    v_mul_u32_u24 v19, 18432, v17
    v_lshl_add_u32 v24, v18, 4, v19
    v_mul_u32_u24 v19, 576, v17
    v_lshrrev_b32 v20, 2, v18
    v_lshl_add_u32 v19, v20, 6, v19
    v_and_b32 v20, 1, v18
    v_lshl_add_u32 v19, v20, 5, v19
    v_bfe_u32 v20, v18, 1, 1
    v_lshl_add_u32 v19, v20, 3, v19
    v_add_u32 v27, 151552, v19
    v_add_u32 v16, 64, v0
    v_mul_u32_u24 v17, 1821, v16
    v_lshrrev_b32 v17, 16, v17
    v_mul_u32_u24 v18, 36, v17
    v_sub_u32 v18, v16, v18
    v_mul_u32_u24 v19, 18432, v17
    v_lshl_add_u32 v25, v18, 4, v19
    v_mul_u32_u24 v19, 576, v17
    v_lshrrev_b32 v20, 2, v18
    v_lshl_add_u32 v19, v20, 6, v19
    v_and_b32 v20, 1, v18
    v_lshl_add_u32 v19, v20, 5, v19
    v_bfe_u32 v20, v18, 1, 1
    v_lshl_add_u32 v19, v20, 3, v19
    v_add_u32 v28, 151552, v19
    v_add_u32 v16, 128, v0
    v_mul_u32_u24 v17, 1821, v16
    v_lshrrev_b32 v17, 16, v17
    v_mul_u32_u24 v18, 36, v17
    v_sub_u32 v18, v16, v18
    v_mul_u32_u24 v19, 18432, v17
    v_lshl_add_u32 v26, v18, 4, v19
    v_mul_u32_u24 v19, 576, v17
    v_lshrrev_b32 v20, 2, v18
    v_lshl_add_u32 v19, v20, 6, v19
    v_and_b32 v20, 1, v18
    v_lshl_add_u32 v19, v20, 5, v19
    v_bfe_u32 v20, v18, 1, 1
    v_lshl_add_u32 v19, v20, 3, v19
    v_add_u32 v29, 151552, v19
    v_cmp_gt_u32 vcc, 16, v0
    s_nop 1
    v_cndmask_b32 v26, v24, v26, vcc
    v_cndmask_b32 v29, v27, v29, vcc
    s_sub_u32 s46, s37, 16
    s_mul_i32 s46, s46, 576
    s_add_u32 s47, s46, 41984
    s_add_u32 s46, s46, 32768
Lw_30:
    ds_read_b32 v14, v15
    s_waitcnt lgkmcnt(0)
    v_readfirstlane_b32 s48, v14
    s_cmp_ge_i32 s48, 262
    s_cbranch_scc1 Ld_31
    s_sleep 4
    s_sub_i32 s69, s69, 1
    s_cmp_gt_i32 s69, 0
    s_cbranch_scc1 Lw_30
Ld_31:
    s_mov_b32 s59, 65536
    s_mov_b64 s[90:91], exec
    buffer_load_dwordx4 v[48:51], v24, s[40:43], s46 offen sc1
    buffer_load_dwordx4 v[60:63], v24, s[40:43], s47 offen sc1
    buffer_load_dwordx4 v[52:55], v25, s[40:43], s46 offen sc1
    buffer_load_dwordx4 v[64:67], v25, s[40:43], s47 offen sc1
    buffer_load_dwordx4 v[56:59], v26, s[40:43], s46 offen sc1
    buffer_load_dwordx4 v[68:71], v26, s[40:43], s47 offen sc1
    s_branch Lgp_34
Lg_32:
    s_mov_b64 exec, s[4:5]
    s_cbranch_execz Lgs_35
    buffer_load_dwordx4 v[48:51], v24, s[40:43], s46 offen sc1
Lgs_35:
    s_mov_b64 exec, s[6:7]
    s_cbranch_execz Lgs_36
    buffer_load_dwordx4 v[60:63], v24, s[40:43], s47 offen sc1
Lgs_36:
    s_mov_b64 exec, s[8:9]
    s_cbranch_execz Lgs_37
    buffer_load_dwordx4 v[52:55], v25, s[40:43], s46 offen sc1
Lgs_37:
    s_mov_b64 exec, s[10:11]
    s_cbranch_execz Lgs_38
    buffer_load_dwordx4 v[64:67], v25, s[40:43], s47 offen sc1
Lgs_38:
    s_mov_b64 exec, s[12:13]
    s_cbranch_execz Lgs_39
    buffer_load_dwordx4 v[56:59], v26, s[40:43], s46 offen sc1
Lgs_39:
    s_mov_b64 exec, s[14:15]
    s_cbranch_execz Lgs_40
    buffer_load_dwordx4 v[68:71], v26, s[40:43], s47 offen sc1
Lgs_40:
    s_mov_b64 exec, s[90:91]
Lgp_34:
    s_waitcnt vmcnt(0)
    v_max3_u32 v72, v48, v49, v50
    v_max_u32 v72, v72, v51
    v_max3_u32 v73, v60, v61, v62
    v_max_u32 v73, v73, v63
    v_max3_u32 v74, v52, v53, v54
    v_max_u32 v74, v74, v55
    v_max3_u32 v75, v64, v65, v66
    v_max_u32 v75, v75, v67
    v_max3_u32 v76, v56, v57, v58
    v_max_u32 v76, v76, v59
    v_max3_u32 v77, v68, v69, v70
    v_max_u32 v77, v77, v71
    v_max_u32 v78, v72, v73
    v_max3_u32 v78, v78, v74, v75
    v_max3_u32 v78, v78, v76, v77
    v_cmp_eq_u32 vcc, -1, v78
    s_cbranch_vccz Lgd_33
    v_cmp_eq_u32 s[4:5], -1, v72
    v_cmp_eq_u32 s[6:7], -1, v73
    v_cmp_eq_u32 s[8:9], -1, v74
    v_cmp_eq_u32 s[10:11], -1, v75
    v_cmp_eq_u32 s[12:13], -1, v76
    v_cmp_eq_u32 s[14:15], -1, v77
    s_sleep 8
    s_sub_u32 s59, s59, 1
    s_cmp_lg_u32 s59, 0
    s_cbranch_scc1 Lg_32
Lgd_33:
    s_mov_b32 s46, 0xc0135761
    s_mov_b32 s47, 0xbdd2d3e8
    s_mov_b32 s56, 0xffff0000
    v_mov_b32 v20, s46
    v_lshlrev_b32 v16, 16, v48
    v_and_b32 v17, s56, v48
    v_mul_f32 v18, v16, v16
    v_mul_f32 v19, v17, v17
    v_fma_f32 v18, v18, s47, v20
    v_fma_f32 v19, v19, s47, v20
    v_mul_f32 v18, v18, v16
    v_mul_f32 v19, v19, v17
    v_exp_f32 v18, v18
    v_exp_f32 v19, v19
    s_nop 0
    v_add_f32 v18, 1.0, v18
    v_add_f32 v19, 1.0, v19
    v_rcp_f32 v18, v18
    v_rcp_f32 v19, v19
    s_nop 0
    v_mul_f32 v18, v18, v16
    v_mul_f32 v19, v19, v17
    v_cvt_pk_bf16_f32 v18, v18, v19
    v_lshlrev_b32 v16, 16, v60
    v_and_b32 v17, s56, v60
    v_and_b32 v19, s56, v18
    v_lshlrev_b32 v18, 16, v18
    v_mul_f32 v18, v18, v16
    v_mul_f32 v19, v19, v17
    v_cvt_pk_bf16_f32 v48, v18, v19
    v_lshlrev_b32 v16, 16, v49
    v_and_b32 v17, s56, v49
    v_mul_f32 v18, v16, v16
    v_mul_f32 v19, v17, v17
    v_fma_f32 v18, v18, s47, v20
    v_fma_f32 v19, v19, s47, v20
    v_mul_f32 v18, v18, v16
    v_mul_f32 v19, v19, v17
    v_exp_f32 v18, v18
    v_exp_f32 v19, v19
    s_nop 0
    v_add_f32 v18, 1.0, v18
    v_add_f32 v19, 1.0, v19
    v_rcp_f32 v18, v18
    v_rcp_f32 v19, v19
    s_nop 0
    v_mul_f32 v18, v18, v16
    v_mul_f32 v19, v19, v17
    v_cvt_pk_bf16_f32 v18, v18, v19
    v_lshlrev_b32 v16, 16, v61
    v_and_b32 v17, s56, v61
    v_and_b32 v19, s56, v18
    v_lshlrev_b32 v18, 16, v18
    v_mul_f32 v18, v18, v16
    v_mul_f32 v19, v19, v17
    v_cvt_pk_bf16_f32 v49, v18, v19
    v_lshlrev_b32 v16, 16, v50
    v_and_b32 v17, s56, v50
    v_mul_f32 v18, v16, v16
    v_mul_f32 v19, v17, v17
    v_fma_f32 v18, v18, s47, v20
    v_fma_f32 v19, v19, s47, v20
    v_mul_f32 v18, v18, v16
    v_mul_f32 v19, v19, v17
    v_exp_f32 v18, v18
    v_exp_f32 v19, v19
    s_nop 0
    v_add_f32 v18, 1.0, v18
    v_add_f32 v19, 1.0, v19
    v_rcp_f32 v18, v18
    v_rcp_f32 v19, v19
    s_nop 0
    v_mul_f32 v18, v18, v16
    v_mul_f32 v19, v19, v17
    v_cvt_pk_bf16_f32 v18, v18, v19
    v_lshlrev_b32 v16, 16, v62
    v_and_b32 v17, s56, v62
    v_and_b32 v19, s56, v18
    v_lshlrev_b32 v18, 16, v18
    v_mul_f32 v18, v18, v16
    v_mul_f32 v19, v19, v17
    v_cvt_pk_bf16_f32 v50, v18, v19
    v_lshlrev_b32 v16, 16, v51
    v_and_b32 v17, s56, v51
    v_mul_f32 v18, v16, v16
    v_mul_f32 v19, v17, v17
    v_fma_f32 v18, v18, s47, v20
    v_fma_f32 v19, v19, s47, v20
    v_mul_f32 v18, v18, v16
    v_mul_f32 v19, v19, v17
    v_exp_f32 v18, v18
    v_exp_f32 v19, v19
    s_nop 0
    v_add_f32 v18, 1.0, v18
    v_add_f32 v19, 1.0, v19
    v_rcp_f32 v18, v18
    v_rcp_f32 v19, v19
    s_nop 0
    v_mul_f32 v18, v18, v16
    v_mul_f32 v19, v19, v17
    v_cvt_pk_bf16_f32 v18, v18, v19
    v_lshlrev_b32 v16, 16, v63
    v_and_b32 v17, s56, v63
    v_and_b32 v19, s56, v18
    v_lshlrev_b32 v18, 16, v18
    v_mul_f32 v18, v18, v16
    v_mul_f32 v19, v19, v17
    v_cvt_pk_bf16_f32 v51, v18, v19
    v_lshlrev_b32 v16, 16, v52
    v_and_b32 v17, s56, v52
    v_mul_f32 v18, v16, v16
    v_mul_f32 v19, v17, v17
    v_fma_f32 v18, v18, s47, v20
    v_fma_f32 v19, v19, s47, v20
    v_mul_f32 v18, v18, v16
    v_mul_f32 v19, v19, v17
    v_exp_f32 v18, v18
    v_exp_f32 v19, v19
    s_nop 0
    v_add_f32 v18, 1.0, v18
    v_add_f32 v19, 1.0, v19
    v_rcp_f32 v18, v18
    v_rcp_f32 v19, v19
    s_nop 0
    v_mul_f32 v18, v18, v16
    v_mul_f32 v19, v19, v17
    v_cvt_pk_bf16_f32 v18, v18, v19
    v_lshlrev_b32 v16, 16, v64
    v_and_b32 v17, s56, v64
    v_and_b32 v19, s56, v18
    v_lshlrev_b32 v18, 16, v18
    v_mul_f32 v18, v18, v16
    v_mul_f32 v19, v19, v17
    v_cvt_pk_bf16_f32 v52, v18, v19
    v_lshlrev_b32 v16, 16, v53
    v_and_b32 v17, s56, v53
    v_mul_f32 v18, v16, v16
    v_mul_f32 v19, v17, v17
    v_fma_f32 v18, v18, s47, v20
    v_fma_f32 v19, v19, s47, v20
    v_mul_f32 v18, v18, v16
    v_mul_f32 v19, v19, v17
    v_exp_f32 v18, v18
    v_exp_f32 v19, v19
    s_nop 0
    v_add_f32 v18, 1.0, v18
    v_add_f32 v19, 1.0, v19
    v_rcp_f32 v18, v18
    v_rcp_f32 v19, v19
    s_nop 0
    v_mul_f32 v18, v18, v16
    v_mul_f32 v19, v19, v17
    v_cvt_pk_bf16_f32 v18, v18, v19
    v_lshlrev_b32 v16, 16, v65
    v_and_b32 v17, s56, v65
    v_and_b32 v19, s56, v18
    v_lshlrev_b32 v18, 16, v18
    v_mul_f32 v18, v18, v16
    v_mul_f32 v19, v19, v17
    v_cvt_pk_bf16_f32 v53, v18, v19
    v_lshlrev_b32 v16, 16, v54
    v_and_b32 v17, s56, v54
    v_mul_f32 v18, v16, v16
    v_mul_f32 v19, v17, v17
    v_fma_f32 v18, v18, s47, v20
    v_fma_f32 v19, v19, s47, v20
    v_mul_f32 v18, v18, v16
    v_mul_f32 v19, v19, v17
    v_exp_f32 v18, v18
    v_exp_f32 v19, v19
    s_nop 0
    v_add_f32 v18, 1.0, v18
    v_add_f32 v19, 1.0, v19
    v_rcp_f32 v18, v18
    v_rcp_f32 v19, v19
    s_nop 0
    v_mul_f32 v18, v18, v16
    v_mul_f32 v19, v19, v17
    v_cvt_pk_bf16_f32 v18, v18, v19
    v_lshlrev_b32 v16, 16, v66
    v_and_b32 v17, s56, v66
    v_and_b32 v19, s56, v18
    v_lshlrev_b32 v18, 16, v18
    v_mul_f32 v18, v18, v16
    v_mul_f32 v19, v19, v17
    v_cvt_pk_bf16_f32 v54, v18, v19
    v_lshlrev_b32 v16, 16, v55
    v_and_b32 v17, s56, v55
    v_mul_f32 v18, v16, v16
    v_mul_f32 v19, v17, v17
    v_fma_f32 v18, v18, s47, v20
    v_fma_f32 v19, v19, s47, v20
    v_mul_f32 v18, v18, v16
    v_mul_f32 v19, v19, v17
    v_exp_f32 v18, v18
    v_exp_f32 v19, v19
    s_nop 0
    v_add_f32 v18, 1.0, v18
    v_add_f32 v19, 1.0, v19
    v_rcp_f32 v18, v18
    v_rcp_f32 v19, v19
    s_nop 0
    v_mul_f32 v18, v18, v16
    v_mul_f32 v19, v19, v17
    v_cvt_pk_bf16_f32 v18, v18, v19
    v_lshlrev_b32 v16, 16, v67
    v_and_b32 v17, s56, v67
    v_and_b32 v19, s56, v18
    v_lshlrev_b32 v18, 16, v18
    v_mul_f32 v18, v18, v16
    v_mul_f32 v19, v19, v17
    v_cvt_pk_bf16_f32 v55, v18, v19
    v_lshlrev_b32 v16, 16, v56
    v_and_b32 v17, s56, v56
    v_mul_f32 v18, v16, v16
    v_mul_f32 v19, v17, v17
    v_fma_f32 v18, v18, s47, v20
    v_fma_f32 v19, v19, s47, v20
    v_mul_f32 v18, v18, v16
    v_mul_f32 v19, v19, v17
    v_exp_f32 v18, v18
    v_exp_f32 v19, v19
    s_nop 0
    v_add_f32 v18, 1.0, v18
    v_add_f32 v19, 1.0, v19
    v_rcp_f32 v18, v18
    v_rcp_f32 v19, v19
    s_nop 0
    v_mul_f32 v18, v18, v16
    v_mul_f32 v19, v19, v17
    v_cvt_pk_bf16_f32 v18, v18, v19
    v_lshlrev_b32 v16, 16, v68
    v_and_b32 v17, s56, v68
    v_and_b32 v19, s56, v18
    v_lshlrev_b32 v18, 16, v18
    v_mul_f32 v18, v18, v16
    v_mul_f32 v19, v19, v17
    v_cvt_pk_bf16_f32 v56, v18, v19
    v_lshlrev_b32 v16, 16, v57
    v_and_b32 v17, s56, v57
    v_mul_f32 v18, v16, v16
    v_mul_f32 v19, v17, v17
    v_fma_f32 v18, v18, s47, v20
    v_fma_f32 v19, v19, s47, v20
    v_mul_f32 v18, v18, v16
    v_mul_f32 v19, v19, v17
    v_exp_f32 v18, v18
    v_exp_f32 v19, v19
    s_nop 0
    v_add_f32 v18, 1.0, v18
    v_add_f32 v19, 1.0, v19
    v_rcp_f32 v18, v18
    v_rcp_f32 v19, v19
    s_nop 0
    v_mul_f32 v18, v18, v16
    v_mul_f32 v19, v19, v17
    v_cvt_pk_bf16_f32 v18, v18, v19
    v_lshlrev_b32 v16, 16, v69
    v_and_b32 v17, s56, v69
    v_and_b32 v19, s56, v18
    v_lshlrev_b32 v18, 16, v18
    v_mul_f32 v18, v18, v16
    v_mul_f32 v19, v19, v17
    v_cvt_pk_bf16_f32 v57, v18, v19
    v_lshlrev_b32 v16, 16, v58
    v_and_b32 v17, s56, v58
    v_mul_f32 v18, v16, v16
    v_mul_f32 v19, v17, v17
    v_fma_f32 v18, v18, s47, v20
    v_fma_f32 v19, v19, s47, v20
    v_mul_f32 v18, v18, v16
    v_mul_f32 v19, v19, v17
    v_exp_f32 v18, v18
    v_exp_f32 v19, v19
    s_nop 0
    v_add_f32 v18, 1.0, v18
    v_add_f32 v19, 1.0, v19
    v_rcp_f32 v18, v18
    v_rcp_f32 v19, v19
    s_nop 0
    v_mul_f32 v18, v18, v16
    v_mul_f32 v19, v19, v17
    v_cvt_pk_bf16_f32 v18, v18, v19
    v_lshlrev_b32 v16, 16, v70
    v_and_b32 v17, s56, v70
    v_and_b32 v19, s56, v18
    v_lshlrev_b32 v18, 16, v18
    v_mul_f32 v18, v18, v16
    v_mul_f32 v19, v19, v17
    v_cvt_pk_bf16_f32 v58, v18, v19
    v_lshlrev_b32 v16, 16, v59
    v_and_b32 v17, s56, v59
    v_mul_f32 v18, v16, v16
    v_mul_f32 v19, v17, v17
    v_fma_f32 v18, v18, s47, v20
    v_fma_f32 v19, v19, s47, v20
    v_mul_f32 v18, v18, v16
    v_mul_f32 v19, v19, v17
    v_exp_f32 v18, v18
    v_exp_f32 v19, v19
    s_nop 0
    v_add_f32 v18, 1.0, v18
    v_add_f32 v19, 1.0, v19
    v_rcp_f32 v18, v18
    v_rcp_f32 v19, v19
    s_nop 0
    v_mul_f32 v18, v18, v16
    v_mul_f32 v19, v19, v17
    v_cvt_pk_bf16_f32 v18, v18, v19
    v_lshlrev_b32 v16, 16, v71
    v_and_b32 v17, s56, v71
    v_and_b32 v19, s56, v18
    v_lshlrev_b32 v18, 16, v18
    v_mul_f32 v18, v18, v16
    v_mul_f32 v19, v19, v17
    v_cvt_pk_bf16_f32 v59, v18, v19
    ds_write2_b64 v27, v[48:49], v[50:51] offset0:0 offset1:2
    ds_write2_b64 v28, v[52:53], v[54:55] offset0:0 offset1:2
    ds_write2_b64 v29, v[56:57], v[58:59] offset0:0 offset1:2
    s_waitcnt lgkmcnt(0)
    s_mov_b64 exec, 1
    v_mov_b32 v21, 161404
    v_mov_b32 v22, 1
    ds_write_b32 v21, v22
    s_mov_b64 exec, -1
L_cm_noh:
    v_mov_b32 v16, 161392
Lw_41:
    ds_read_b32 v17, v16
    s_waitcnt lgkmcnt(0)
    v_readfirstlane_b32 s46, v17
    s_cmp_ge_i32 s46, 4
    s_cbranch_scc1 Ld_42
    s_sleep 2
    s_sub_i32 s69, s69, 1
    s_cmp_gt_i32 s69, 0
    s_cbranch_scc1 Lw_41
Ld_42:
    v_and_b32 v16, 7, v0
    v_lshlrev_b32 v16, 3, v16
    v_add_u32 v17, 161296, v16
    ds_read_b64 v[18:19], v17
    s_mov_b32 s56, 0x3fb8aa3b
    v_and_b32 v27, 1, v0
    v_lshlrev_b32 v27, 4, v27
    v_bfe_u32 v28, v0, 1, 2
    v_lshl_add_u32 v27, v28, 2, v27
    v_add_u32 v27, 161360, v27
    s_waitcnt lgkmcnt(0)
    v_max_f32_dpp v20, v18, v18 row_ror:2 row_mask:0xf bank_mask:0xf
    s_nop 1
    v_max_f32_dpp v20, v20, v20 row_ror:4 row_mask:0xf bank_mask:0xf
    v_sub_f32 v22, v18, v20
    v_mul_f32 v22, s56, v22
    v_exp_f32 v22, v22
    s_nop 0
    v_mul_f32 v21, v22, v19
    ds_write_b32 v27, v22
    s_nop 0
    v_add_f32_dpp v21, v21, v21 row_ror:2 row_mask:0xf bank_mask:0xf
    s_nop 1
    v_add_f32_dpp v21, v21, v21 row_ror:4 row_mask:0xf bank_mask:0xf
    s_lshl_b32 s47, s45, 6
    s_add_u32 s47, s47, 106496
    s_mov_b64 exec, 0xff
    buffer_store_dwordx2 v[20:21], v16, s[40:43], s47 offen sc1
    s_mov_b64 exec, -1
    s_waitcnt lgkmcnt(0)
    s_mov_b64 exec, 1
    v_mov_b32 v23, 161408
    v_mov_b32 v24, 1
    ds_write_b32 v23, v24
    s_mov_b64 exec, -1
    s_sub_u32 s46, s31, 8
    s_cmp_ge_u32 s46, 18
    s_cbranch_scc1 L_cm_end
    v_lshrrev_b32 v16, 4, v0
    v_and_b32 v17, 15, v0
    v_lshlrev_b32 v18, 12, v16
    v_lshl_add_u32 v18, v17, 4, v18
    s_lshl_b32 s47, s37, 8
    s_add_u32 s47, s47, 106496
    v_lshrrev_b32 v19, 2, v0
    v_lshlrev_b32 v19, 3, v19
    v_add_u32 v19, 156416, v19
Lw_43:
    ds_read_b32 v14, v15
    s_waitcnt lgkmcnt(0)
    v_readfirstlane_b32 s46, v14
    s_cmp_ge_i32 s46, 312
    s_cbranch_scc1 Ld_44
    s_sleep 4
    s_sub_i32 s69, s69, 1
    s_cmp_gt_i32 s69, 0
    s_cbranch_scc1 Lw_43
Ld_44:
    s_mov_b32 s59, 65536
    s_mov_b64 s[90:91], exec
    buffer_load_dwordx4 v[24:27], v18, s[40:43], s47 offen sc1
    s_branch Lgp_47
Lg_45:
    s_mov_b64 exec, vcc
    buffer_load_dwordx4 v[24:27], v18, s[40:43], s47 offen sc1
    s_mov_b64 exec, s[90:91]
Lgp_47:
    s_waitcnt vmcnt(0)
    v_max3_u32 v20, v24, v25, v26
    v_max_u32 v20, v20, v27
    v_cmp_eq_u32 vcc, -1, v20
    s_cbranch_vccz Lgd_46
    s_sleep 8
    s_sub_u32 s59, s59, 1
    s_cmp_lg_u32 s59, 0
    s_cbranch_scc1 Lg_45
Lgd_46:
    v_max_f32_dpp v28, v24, v24 row_ror:4 row_mask:0xf bank_mask:0xf
    v_max_f32_dpp v29, v26, v26 row_ror:4 row_mask:0xf bank_mask:0xf
    s_nop 0
    v_max_f32_dpp v28, v28, v28 row_ror:8 row_mask:0xf bank_mask:0xf
    v_max_f32_dpp v29, v29, v29 row_ror:8 row_mask:0xf bank_mask:0xf
    v_sub_f32 v28, v24, v28
    v_sub_f32 v29, v26, v29
    v_mul_f32 v28, s56, v28
    v_mul_f32 v29, s56, v29
    v_exp_f32 v28, v28
    v_exp_f32 v29, v29
    s_nop 0
    v_mul_f32 v30, v28, v25
    v_mul_f32 v31, v29, v27
    s_nop 0
    v_add_f32_dpp v30, v30, v30 row_ror:4 row_mask:0xf bank_mask:0xf
    v_add_f32_dpp v31, v31, v31 row_ror:4 row_mask:0xf bank_mask:0xf
    s_nop 0
    v_add_f32_dpp v30, v30, v30 row_ror:8 row_mask:0xf bank_mask:0xf
    v_add_f32_dpp v31, v31, v31 row_ror:8 row_mask:0xf bank_mask:0xf
    v_rcp_f32 v30, v30
    v_rcp_f32 v31, v31
    s_nop 0
    v_mul_f32 v28, v28, v30
    v_mul_f32 v29, v29, v31
    ds_write_b64 v19, v[28:29]
    s_waitcnt lgkmcnt(0)
    s_mov_b64 exec, 1
    v_mov_b32 v23, 161428
    v_mov_b32 v24, 1
    ds_write_b32 v23, v24
    s_mov_b64 exec, -1
L_cm_end:
    s_endpgm
L_cons:
    s_sub_u32 s36, s36, 2
    v_mov_b32 v2, 161024
    s_lshl_b32 s44, s36, 2
    s_add_u32 s44, s44, 161280
    v_mov_b32 v3, s44
    s_mov_b32 s50, 0
    v_and_b32 v8, 15, v0
    v_lshrrev_b32 v9, 4, v0
    v_lshrrev_b32 v10, 2, v0
    v_and_b32 v11, 3, v0
    s_mov_b32 s56, 0xffff0000
    v_mul_u32_u24 v12, 1152, v9
    v_lshl_add_u32 v12, v8, 4, v12
    v_mov_b32 v13, 0x40000000
    v_cmp_gt_u32 vcc, 8, v8
    v_bfe_u32 v7, v0, 3, 2
    v_lshlrev_b32 v7, 5, v7
    v_cndmask_b32 v13, v13, v12, vcc
    v_lshl_add_u32 v7, v10, 7, v7
    v_lshl_add_u32 v7, v11, 3, v7
    s_waitcnt lgkmcnt(0)
    s_mov_b32 s60, s4
    s_mov_b32 s61, s5
    s_mov_b32 s62, 4608
    s_mov_b32 s63, 0x00020000
    s_mov_b32 s40, s26
    s_mov_b32 s41, s27
    s_mov_b32 s42, 679936
    s_mov_b32 s43, 0x00020000
    s_cmp_ge_u32 s31, 26
    s_cbranch_scc1 L_cs_nocol
    buffer_load_dwordx4 v[32:35], v12, s[60:63], 0 offen
    buffer_load_dwordx4 v[36:39], v12, s[60:63], 0 offen offset:256
    buffer_load_dwordx4 v[40:43], v12, s[60:63], 0 offen offset:512
    buffer_load_dwordx4 v[44:47], v12, s[60:63], 0 offen offset:768
    buffer_load_dwordx4 v[48:51], v13, s[60:63], 0 offen offset:1024
    s_barrier
    v_mul_u32_u24 v14, 1216, v9
    v_lshrrev_b32 v15, 2, v8
    v_lshl_add_u32 v14, v15, 6, v14
    v_and_b32 v15, 1, v8
    v_lshl_add_u32 v14, v15, 5, v14
    v_bfe_u32 v15, v8, 1, 1
    v_lshl_add_u32 v14, v15, 3, v14
    v_add_u32 v14, 151552, v14
    s_lshl_b32 s44, s36, 5
    v_xor_b32 v15, s44, v7
    v_mul_u32_u24 v16, 1216, v11
    v_lshl_add_u32 v16, v9, 4, v16
    v_add_u32 v16, 151552, v16
    s_waitcnt vmcnt(0)
    v_lshlrev_b32 v64, 16, v32
    v_and_b32 v65, s56, v32
    v_lshlrev_b32 v66, 16, v33
    v_and_b32 v67, s56, v33
    v_lshlrev_b32 v68, 16, v34
    v_and_b32 v69, s56, v34
    v_lshlrev_b32 v70, 16, v35
    v_and_b32 v71, s56, v35
    v_lshlrev_b32 v72, 16, v36
    v_and_b32 v73, s56, v36
    v_lshlrev_b32 v74, 16, v37
    v_and_b32 v75, s56, v37
    v_lshlrev_b32 v76, 16, v38
    v_and_b32 v77, s56, v38
    v_lshlrev_b32 v78, 16, v39
    v_and_b32 v79, s56, v39
    v_lshlrev_b32 v80, 16, v40
    v_and_b32 v81, s56, v40
    v_lshlrev_b32 v82, 16, v41
    v_and_b32 v83, s56, v41
    v_lshlrev_b32 v84, 16, v42
    v_and_b32 v85, s56, v42
    v_lshlrev_b32 v86, 16, v43
    v_and_b32 v87, s56, v43
    v_lshlrev_b32 v88, 16, v44
    v_and_b32 v89, s56, v44
    v_lshlrev_b32 v90, 16, v45
    v_and_b32 v91, s56, v45
    v_lshlrev_b32 v92, 16, v46
    v_and_b32 v93, s56, v46
    v_lshlrev_b32 v94, 16, v47
    v_and_b32 v95, s56, v47
    v_lshlrev_b32 v96, 16, v48
    v_and_b32 v97, s56, v48
    v_lshlrev_b32 v98, 16, v49
    v_and_b32 v99, s56, v49
    v_lshlrev_b32 v100, 16, v50
    v_and_b32 v101, s56, v50
    v_lshlrev_b32 v102, 16, v51
    v_and_b32 v103, s56, v51
    v_add_f32 v52, v64, v65
    v_add_f32 v53, v66, v67
    v_add_f32 v52, v52, v68
    v_add_f32 v53, v53, v69
    v_add_f32 v52, v52, v70
    v_add_f32 v53, v53, v71
    v_add_f32 v52, v52, v72
    v_add_f32 v53, v53, v73
    v_add_f32 v52, v52, v74
    v_add_f32 v53, v53, v75
    v_add_f32 v52, v52, v76
    v_add_f32 v53, v53, v77
    v_add_f32 v52, v52, v78
    v_add_f32 v53, v53, v79
    v_add_f32 v52, v52, v80
    v_add_f32 v53, v53, v81
    v_add_f32 v52, v52, v82
    v_add_f32 v53, v53, v83
    v_add_f32 v52, v52, v84
    v_add_f32 v53, v53, v85
    v_add_f32 v52, v52, v86
    v_add_f32 v53, v53, v87
    v_add_f32 v52, v52, v88
    v_add_f32 v53, v53, v89
    v_add_f32 v52, v52, v90
    v_add_f32 v53, v53, v91
    v_add_f32 v52, v52, v92
    v_add_f32 v53, v53, v93
    v_add_f32 v52, v52, v94
    v_add_f32 v53, v53, v95
    v_add_f32 v52, v52, v96
    v_add_f32 v53, v53, v97
    v_add_f32 v52, v52, v98
    v_add_f32 v53, v53, v99
    v_add_f32 v52, v52, v100
    v_add_f32 v53, v53, v101
    v_add_f32 v52, v52, v102
    v_add_f32 v53, v53, v103
    v_add_f32 v52, v52, v53
    s_nop 1
    v_add_f32_dpp v52, v52, v52 row_ror:8 row_mask:0xf bank_mask:0xf
    s_nop 1
    v_add_f32_dpp v52, v52, v52 row_ror:4 row_mask:0xf bank_mask:0xf
    s_nop 1
    v_add_f32_dpp v52, v52, v52 row_ror:2 row_mask:0xf bank_mask:0xf
    s_nop 1
    v_add_f32_dpp v52, v52, v52 row_ror:1 row_mask:0xf bank_mask:0xf
    v_mul_f32 v52, 0x3ae38e39, v52
    v_cndmask_b32 v55, 0, v52, vcc
    v_mov_b32 v53, 0
    v_mov_b32 v54, 0
    v_sub_f32 v56, v64, v52
    v_sub_f32 v57, v65, v52
    v_fmac_f32 v53, v56, v56
    v_fmac_f32 v54, v57, v57
    v_sub_f32 v56, v66, v52
    v_sub_f32 v57, v67, v52
    v_fmac_f32 v53, v56, v56
    v_fmac_f32 v54, v57, v57
    v_sub_f32 v56, v68, v52
    v_sub_f32 v57, v69, v52
    v_fmac_f32 v53, v56, v56
    v_fmac_f32 v54, v57, v57
    v_sub_f32 v56, v70, v52
    v_sub_f32 v57, v71, v52
    v_fmac_f32 v53, v56, v56
    v_fmac_f32 v54, v57, v57
    v_sub_f32 v56, v72, v52
    v_sub_f32 v57, v73, v52
    v_fmac_f32 v53, v56, v56
    v_fmac_f32 v54, v57, v57
    v_sub_f32 v56, v74, v52
    v_sub_f32 v57, v75, v52
    v_fmac_f32 v53, v56, v56
    v_fmac_f32 v54, v57, v57
    v_sub_f32 v56, v76, v52
    v_sub_f32 v57, v77, v52
    v_fmac_f32 v53, v56, v56
    v_fmac_f32 v54, v57, v57
    v_sub_f32 v56, v78, v52
    v_sub_f32 v57, v79, v52
    v_fmac_f32 v53, v56, v56
    v_fmac_f32 v54, v57, v57
    v_sub_f32 v56, v80, v52
    v_sub_f32 v57, v81, v52
    v_fmac_f32 v53, v56, v56
    v_fmac_f32 v54, v57, v57
    v_sub_f32 v56, v82, v52
    v_sub_f32 v57, v83, v52
    v_fmac_f32 v53, v56, v56
    v_fmac_f32 v54, v57, v57
    v_sub_f32 v56, v84, v52
    v_sub_f32 v57, v85, v52
    v_fmac_f32 v53, v56, v56
    v_fmac_f32 v54, v57, v57
    v_sub_f32 v56, v86, v52
    v_sub_f32 v57, v87, v52
    v_fmac_f32 v53, v56, v56
    v_fmac_f32 v54, v57, v57
    v_sub_f32 v56, v88, v52
    v_sub_f32 v57, v89, v52
    v_fmac_f32 v53, v56, v56
    v_fmac_f32 v54, v57, v57
    v_sub_f32 v56, v90, v52
    v_sub_f32 v57, v91, v52
    v_fmac_f32 v53, v56, v56
    v_fmac_f32 v54, v57, v57
    v_sub_f32 v56, v92, v52
    v_sub_f32 v57, v93, v52
    v_fmac_f32 v53, v56, v56
    v_fmac_f32 v54, v57, v57
    v_sub_f32 v56, v94, v52
    v_sub_f32 v57, v95, v52
    v_fmac_f32 v53, v56, v56
    v_fmac_f32 v54, v57, v57
    v_sub_f32 v56, v96, v55
    v_sub_f32 v57, v97, v55
    v_fmac_f32 v53, v56, v56
    v_fmac_f32 v54, v57, v57
    v_sub_f32 v56, v98, v55
    v_sub_f32 v57, v99, v55
    v_fmac_f32 v53, v56, v56
    v_fmac_f32 v54, v57, v57
    v_sub_f32 v56, v100, v55
    v_sub_f32 v57, v101, v55
    v_fmac_f32 v53, v56, v56
    v_fmac_f32 v54, v57, v57
    v_sub_f32 v56, v102, v55
    v_sub_f32 v57, v103, v55
    v_fmac_f32 v53, v56, v56
    v_fmac_f32 v54, v57, v57
    v_add_f32 v53, v53, v54
    s_nop 1
    v_add_f32_dpp v53, v53, v53 row_ror:8 row_mask:0xf bank_mask:0xf
    s_nop 1
    v_add_f32_dpp v53, v53, v53 row_ror:4 row_mask:0xf bank_mask:0xf
    s_nop 1
    v_add_f32_dpp v53, v53, v53 row_ror:2 row_mask:0xf bank_mask:0xf
    s_nop 1
    v_add_f32_dpp v53, v53, v53 row_ror:1 row_mask:0xf bank_mask:0xf
    v_mul_f32 v53, 0x3ae38e39, v53
    v_cvt_pk_bf16_f32 v52, v52, v53
    v_and_b32 v53, s56, v52
    v_lshlrev_b32 v52, 16, v52
    v_add_f32 v53, 0x3727c5ac, v53
    v_cvt_pk_bf16_f32 v53, v53, v53
    v_and_b32 v53, s56, v53
    v_sqrt_f32 v53, v53
    s_nop 0
    v_cvt_pk_bf16_f32 v53, v53, v53
    v_and_b32 v53, s56, v53
    v_rcp_f32 v54, v53
    v_sub_f32 v64, v64, v52
    v_sub_f32 v65, v65, v52
    v_cvt_pk_bf16_f32 v56, v64, v65
    v_lshlrev_b32 v64, 16, v56
    v_and_b32 v65, s56, v56
    v_mul_f32 v57, v64, v54
    v_mul_f32 v58, v65, v54
    v_fma_f32 v64, -v57, v53, v64
    v_fma_f32 v65, -v58, v53, v65
    v_fmac_f32 v57, v64, v54
    v_fmac_f32 v58, v65, v54
    v_cvt_pk_bf16_f32 v32, v57, v58
    v_sub_f32 v66, v66, v52
    v_sub_f32 v67, v67, v52
    v_cvt_pk_bf16_f32 v56, v66, v67
    v_lshlrev_b32 v66, 16, v56
    v_and_b32 v67, s56, v56
    v_mul_f32 v57, v66, v54
    v_mul_f32 v58, v67, v54
    v_fma_f32 v66, -v57, v53, v66
    v_fma_f32 v67, -v58, v53, v67
    v_fmac_f32 v57, v66, v54
    v_fmac_f32 v58, v67, v54
    v_cvt_pk_bf16_f32 v33, v57, v58
    v_sub_f32 v68, v68, v52
    v_sub_f32 v69, v69, v52
    v_cvt_pk_bf16_f32 v56, v68, v69
    v_lshlrev_b32 v68, 16, v56
    v_and_b32 v69, s56, v56
    v_mul_f32 v57, v68, v54
    v_mul_f32 v58, v69, v54
    v_fma_f32 v68, -v57, v53, v68
    v_fma_f32 v69, -v58, v53, v69
    v_fmac_f32 v57, v68, v54
    v_fmac_f32 v58, v69, v54
    v_cvt_pk_bf16_f32 v34, v57, v58
    v_sub_f32 v70, v70, v52
    v_sub_f32 v71, v71, v52
    v_cvt_pk_bf16_f32 v56, v70, v71
    v_lshlrev_b32 v70, 16, v56
    v_and_b32 v71, s56, v56
    v_mul_f32 v57, v70, v54
    v_mul_f32 v58, v71, v54
    v_fma_f32 v70, -v57, v53, v70
    v_fma_f32 v71, -v58, v53, v71
    v_fmac_f32 v57, v70, v54
    v_fmac_f32 v58, v71, v54
    v_cvt_pk_bf16_f32 v35, v57, v58
    v_sub_f32 v72, v72, v52
    v_sub_f32 v73, v73, v52
    v_cvt_pk_bf16_f32 v56, v72, v73
    v_lshlrev_b32 v72, 16, v56
    v_and_b32 v73, s56, v56
    v_mul_f32 v57, v72, v54
    v_mul_f32 v58, v73, v54
    v_fma_f32 v72, -v57, v53, v72
    v_fma_f32 v73, -v58, v53, v73
    v_fmac_f32 v57, v72, v54
    v_fmac_f32 v58, v73, v54
    v_cvt_pk_bf16_f32 v36, v57, v58
    v_sub_f32 v74, v74, v52
    v_sub_f32 v75, v75, v52
    v_cvt_pk_bf16_f32 v56, v74, v75
    v_lshlrev_b32 v74, 16, v56
    v_and_b32 v75, s56, v56
    v_mul_f32 v57, v74, v54
    v_mul_f32 v58, v75, v54
    v_fma_f32 v74, -v57, v53, v74
    v_fma_f32 v75, -v58, v53, v75
    v_fmac_f32 v57, v74, v54
    v_fmac_f32 v58, v75, v54
    v_cvt_pk_bf16_f32 v37, v57, v58
    v_sub_f32 v76, v76, v52
    v_sub_f32 v77, v77, v52
    v_cvt_pk_bf16_f32 v56, v76, v77
    v_lshlrev_b32 v76, 16, v56
    v_and_b32 v77, s56, v56
    v_mul_f32 v57, v76, v54
    v_mul_f32 v58, v77, v54
    v_fma_f32 v76, -v57, v53, v76
    v_fma_f32 v77, -v58, v53, v77
    v_fmac_f32 v57, v76, v54
    v_fmac_f32 v58, v77, v54
    v_cvt_pk_bf16_f32 v38, v57, v58
    v_sub_f32 v78, v78, v52
    v_sub_f32 v79, v79, v52
    v_cvt_pk_bf16_f32 v56, v78, v79
    v_lshlrev_b32 v78, 16, v56
    v_and_b32 v79, s56, v56
    v_mul_f32 v57, v78, v54
    v_mul_f32 v58, v79, v54
    v_fma_f32 v78, -v57, v53, v78
    v_fma_f32 v79, -v58, v53, v79
    v_fmac_f32 v57, v78, v54
    v_fmac_f32 v58, v79, v54
    v_cvt_pk_bf16_f32 v39, v57, v58
    v_sub_f32 v80, v80, v52
    v_sub_f32 v81, v81, v52
    v_cvt_pk_bf16_f32 v56, v80, v81
    v_lshlrev_b32 v80, 16, v56
    v_and_b32 v81, s56, v56
    v_mul_f32 v57, v80, v54
    v_mul_f32 v58, v81, v54
    v_fma_f32 v80, -v57, v53, v80
    v_fma_f32 v81, -v58, v53, v81
    v_fmac_f32 v57, v80, v54
    v_fmac_f32 v58, v81, v54
    v_cvt_pk_bf16_f32 v40, v57, v58
    v_sub_f32 v82, v82, v52
    v_sub_f32 v83, v83, v52
    v_cvt_pk_bf16_f32 v56, v82, v83
    v_lshlrev_b32 v82, 16, v56
    v_and_b32 v83, s56, v56
    v_mul_f32 v57, v82, v54
    v_mul_f32 v58, v83, v54
    v_fma_f32 v82, -v57, v53, v82
    v_fma_f32 v83, -v58, v53, v83
    v_fmac_f32 v57, v82, v54
    v_fmac_f32 v58, v83, v54
    v_cvt_pk_bf16_f32 v41, v57, v58
    v_sub_f32 v84, v84, v52
    v_sub_f32 v85, v85, v52
    v_cvt_pk_bf16_f32 v56, v84, v85
    v_lshlrev_b32 v84, 16, v56
    v_and_b32 v85, s56, v56
    v_mul_f32 v57, v84, v54
    v_mul_f32 v58, v85, v54
    v_fma_f32 v84, -v57, v53, v84
    v_fma_f32 v85, -v58, v53, v85
    v_fmac_f32 v57, v84, v54
    v_fmac_f32 v58, v85, v54
    v_cvt_pk_bf16_f32 v42, v57, v58
    v_sub_f32 v86, v86, v52
    v_sub_f32 v87, v87, v52
    v_cvt_pk_bf16_f32 v56, v86, v87
    v_lshlrev_b32 v86, 16, v56
    v_and_b32 v87, s56, v56
    v_mul_f32 v57, v86, v54
    v_mul_f32 v58, v87, v54
    v_fma_f32 v86, -v57, v53, v86
    v_fma_f32 v87, -v58, v53, v87
    v_fmac_f32 v57, v86, v54
    v_fmac_f32 v58, v87, v54
    v_cvt_pk_bf16_f32 v43, v57, v58
    v_sub_f32 v88, v88, v52
    v_sub_f32 v89, v89, v52
    v_cvt_pk_bf16_f32 v56, v88, v89
    v_lshlrev_b32 v88, 16, v56
    v_and_b32 v89, s56, v56
    v_mul_f32 v57, v88, v54
    v_mul_f32 v58, v89, v54
    v_fma_f32 v88, -v57, v53, v88
    v_fma_f32 v89, -v58, v53, v89
    v_fmac_f32 v57, v88, v54
    v_fmac_f32 v58, v89, v54
    v_cvt_pk_bf16_f32 v44, v57, v58
    v_sub_f32 v90, v90, v52
    v_sub_f32 v91, v91, v52
    v_cvt_pk_bf16_f32 v56, v90, v91
    v_lshlrev_b32 v90, 16, v56
    v_and_b32 v91, s56, v56
    v_mul_f32 v57, v90, v54
    v_mul_f32 v58, v91, v54
    v_fma_f32 v90, -v57, v53, v90
    v_fma_f32 v91, -v58, v53, v91
    v_fmac_f32 v57, v90, v54
    v_fmac_f32 v58, v91, v54
    v_cvt_pk_bf16_f32 v45, v57, v58
    v_sub_f32 v92, v92, v52
    v_sub_f32 v93, v93, v52
    v_cvt_pk_bf16_f32 v56, v92, v93
    v_lshlrev_b32 v92, 16, v56
    v_and_b32 v93, s56, v56
    v_mul_f32 v57, v92, v54
    v_mul_f32 v58, v93, v54
    v_fma_f32 v92, -v57, v53, v92
    v_fma_f32 v93, -v58, v53, v93
    v_fmac_f32 v57, v92, v54
    v_fmac_f32 v58, v93, v54
    v_cvt_pk_bf16_f32 v46, v57, v58
    v_sub_f32 v94, v94, v52
    v_sub_f32 v95, v95, v52
    v_cvt_pk_bf16_f32 v56, v94, v95
    v_lshlrev_b32 v94, 16, v56
    v_and_b32 v95, s56, v56
    v_mul_f32 v57, v94, v54
    v_mul_f32 v58, v95, v54
    v_fma_f32 v94, -v57, v53, v94
    v_fma_f32 v95, -v58, v53, v95
    v_fmac_f32 v57, v94, v54
    v_fmac_f32 v58, v95, v54
    v_cvt_pk_bf16_f32 v47, v57, v58
    v_sub_f32 v96, v96, v52
    v_sub_f32 v97, v97, v52
    v_cvt_pk_bf16_f32 v56, v96, v97
    v_lshlrev_b32 v96, 16, v56
    v_and_b32 v97, s56, v56
    v_mul_f32 v57, v96, v54
    v_mul_f32 v58, v97, v54
    v_fma_f32 v96, -v57, v53, v96
    v_fma_f32 v97, -v58, v53, v97
    v_fmac_f32 v57, v96, v54
    v_fmac_f32 v58, v97, v54
    v_cvt_pk_bf16_f32 v48, v57, v58
    v_sub_f32 v98, v98, v52
    v_sub_f32 v99, v99, v52
    v_cvt_pk_bf16_f32 v56, v98, v99
    v_lshlrev_b32 v98, 16, v56
    v_and_b32 v99, s56, v56
    v_mul_f32 v57, v98, v54
    v_mul_f32 v58, v99, v54
    v_fma_f32 v98, -v57, v53, v98
    v_fma_f32 v99, -v58, v53, v99
    v_fmac_f32 v57, v98, v54
    v_fmac_f32 v58, v99, v54
    v_cvt_pk_bf16_f32 v49, v57, v58
    v_sub_f32 v100, v100, v52
    v_sub_f32 v101, v101, v52
    v_cvt_pk_bf16_f32 v56, v100, v101
    v_lshlrev_b32 v100, 16, v56
    v_and_b32 v101, s56, v56
    v_mul_f32 v57, v100, v54
    v_mul_f32 v58, v101, v54
    v_fma_f32 v100, -v57, v53, v100
    v_fma_f32 v101, -v58, v53, v101
    v_fmac_f32 v57, v100, v54
    v_fmac_f32 v58, v101, v54
    v_cvt_pk_bf16_f32 v50, v57, v58
    v_sub_f32 v102, v102, v52
    v_sub_f32 v103, v103, v52
    v_cvt_pk_bf16_f32 v56, v102, v103
    v_lshlrev_b32 v102, 16, v56
    v_and_b32 v103, s56, v56
    v_mul_f32 v57, v102, v54
    v_mul_f32 v58, v103, v54
    v_fma_f32 v102, -v57, v53, v102
    v_fma_f32 v103, -v58, v53, v103
    v_fmac_f32 v57, v102, v54
    v_fmac_f32 v58, v103, v54
    v_cvt_pk_bf16_f32 v51, v57, v58
    ds_write2_b64 v14, v[32:33], v[34:35] offset0:0 offset1:2
    ds_write2_b64 v14, v[36:37], v[38:39] offset0:32 offset1:34
    ds_write2_b64 v14, v[40:41], v[42:43] offset0:64 offset1:66
    ds_write2_b64 v14, v[44:45], v[46:47] offset0:96 offset1:98
    s_mov_b64 exec, vcc
    ds_write2_b64 v14, v[48:49], v[50:51] offset0:128 offset1:130
    s_mov_b64 exec, -1
    v_mov_b32 v20, 0
    v_mov_b32 v21, 0
    v_mov_b32 v22, 0
    v_mov_b32 v23, 0
    s_mov_b32 s51, 4
Lcol_48:
    s_cmp_ge_i32 s50, s51
    s_cbranch_scc1 Ld_50
Lw_49:
    ds_read_b32 v4, v2
    s_waitcnt lgkmcnt(0)
    v_readfirstlane_b32 s50, v4
    s_cmp_ge_i32 s50, s51
    s_cbranch_scc1 Ld_50
    s_sub_i32 s69, s69, 1
    s_cmp_gt_i32 s69, 0
    s_cbranch_scc1 Lw_49
Ld_50:
    ds_read_b64_tr_b16 v[24:25], v15
    ds_read_b64_tr_b16 v[26:27], v15 offset:2048
    ds_read_b128 v[28:31], v16
    v_add_u32 v15, 4096, v15
    v_add_u32 v16, 64, v16
    s_add_u32 s51, s51, 4
    s_cmp_le_u32 s51, 72
    s_waitcnt lgkmcnt(0)
    v_mfma_f32_16x16x32_bf16 v[20:23], v[24:27], v[28:31], v[20:23]
    s_cbranch_scc1 Lcol_48
    s_lshl_b32 s45, s36, 5
    s_add_u32 s45, s45, 161536
    v_lshlrev_b32 v17, 7, v11
    v_lshl_add_u32 v17, v9, 3, v17
    v_add_u32 v17, s45, v17
    v_mov_b32 v18, 161416
    v_mov_b32 v19, 1
    s_nop 2
    v_cvt_pk_bf16_f32 v24, v20, v21
    v_cvt_pk_bf16_f32 v25, v22, v23
    s_mov_b32 exec_lo, 0x000f000f
    s_mov_b32 exec_hi, 0x000f000f
    ds_write_b64 v17, v[24:25]
    s_mov_b64 exec, 1
    ds_add_u32 v18, v19
    s_mov_b64 exec, -1
    s_branch L_cs_k
L_cs_nocol:
    s_barrier
L_cs_k:
    v_and_b32 v5, 7, v0
    v_lshlrev_b32 v5, 1, v5
    v_xor_b32 v5, v5, v9
    v_lshlrev_b32 v5, 4, v5
    v_lshl_add_u32 v5, v8, 8, v5
    v_and_b32 v6, 7, v10
    v_lshlrev_b32 v6, 5, v6
    v_lshl_add_u32 v6, v10, 8, v6
    v_lshl_add_u32 v6, v11, 3, v6
    s_lshl_b32 s52, s36, 2
    s_add_u32 s51, s52, 72
    s_lshl_b32 s53, s51, 10
    s_mov_b64 exec, 1
    v_mov_b32 v4, s51
    ds_write_b32 v3, v4
    s_mov_b64 exec, -1
    s_add_u32 s55, s51, 4
    s_cmp_ge_i32 s50, s55
    s_cbranch_scc1 Ld_52
Lw_51:
    ds_read_b32 v4, v2
    s_waitcnt lgkmcnt(0)
    v_readfirstlane_b32 s50, v4
    s_cmp_ge_i32 s50, s55
    s_cbranch_scc1 Ld_52
    s_sub_i32 s69, s69, 1
    s_cmp_gt_i32 s69, 0
    s_cbranch_scc1 Lw_51
Ld_52:
    v_add_u32 v12, s53, v5
    v_xor_b32 v13, 64, v12
    v_xor_b32 v14, 0x80, v12
    v_xor_b32 v15, 0xc0, v12
    ds_read_b128 v[128:131], v12
    ds_read_b128 v[132:135], v13
    ds_read_b128 v[136:139], v14
    ds_read_b128 v[140:143], v15
    s_add_u32 s51, s51, 16
    s_add_u32 s53, s53, 16384
    s_sub_u32 s54, s53, 151552
    s_cmp_ge_u32 s53, 151552
    s_cselect_b32 s53, s54, s53
    s_add_u32 s55, s51, 4
    s_cmp_ge_i32 s50, s55
    s_cbranch_scc1 Ld_54
Lw_53:
    ds_read_b32 v4, v2
    s_waitcnt lgkmcnt(0)
    v_readfirstlane_b32 s50, v4
    s_cmp_ge_i32 s50, s55
    s_cbranch_scc1 Ld_54
    s_sub_i32 s69, s69, 1
    s_cmp_gt_i32 s69, 0
    s_cbranch_scc1 Lw_53
Ld_54:
    v_add_u32 v12, s53, v5
    v_xor_b32 v13, 64, v12
    v_xor_b32 v14, 0x80, v12
    v_xor_b32 v15, 0xc0, v12
    ds_read_b128 v[144:147], v12
    ds_read_b128 v[148:151], v13
    ds_read_b128 v[152:155], v14
    ds_read_b128 v[156:159], v15
    s_add_u32 s51, s51, 16
    s_add_u32 s53, s53, 16384
    s_sub_u32 s54, s53, 151552
    s_cmp_ge_u32 s53, 151552
    s_cselect_b32 s53, s54, s53
    s_waitcnt lgkmcnt(0)
    s_mov_b64 exec, 1
    v_mov_b32 v4, s51
    ds_write_b32 v3, v4
    s_mov_b64 exec, -1
    s_add_u32 s55, s51, 4
    s_cmp_ge_i32 s50, s55
    s_cbranch_scc1 Ld_56
Lw_55:
    ds_read_b32 v4, v2
    s_waitcnt lgkmcnt(0)
    v_readfirstlane_b32 s50, v4
    s_cmp_ge_i32 s50, s55
    s_cbranch_scc1 Ld_56
    s_sub_i32 s69, s69, 1
    s_cmp_gt_i32 s69, 0
    s_cbranch_scc1 Lw_55
Ld_56:
    v_add_u32 v12, s53, v5
    v_xor_b32 v13, 64, v12
    v_xor_b32 v14, 0x80, v12
    v_xor_b32 v15, 0xc0, v12
    ds_read_b128 v[160:163], v12
    ds_read_b128 v[164:167], v13
    ds_read_b128 v[168:171], v14
    ds_read_b128 v[172:175], v15
    s_add_u32 s51, s51, 16
    s_add_u32 s53, s53, 16384
    s_sub_u32 s54, s53, 151552
    s_cmp_ge_u32 s53, 151552
    s_cselect_b32 s53, s54, s53
    s_add_u32 s55, s51, 4
    s_cmp_ge_i32 s50, s55
    s_cbranch_scc1 Ld_58
Lw_57:
    ds_read_b32 v4, v2
    s_waitcnt lgkmcnt(0)
    v_readfirstlane_b32 s50, v4
    s_cmp_ge_i32 s50, s55
    s_cbranch_scc1 Ld_58
    s_sub_i32 s69, s69, 1
    s_cmp_gt_i32 s69, 0
    s_cbranch_scc1 Lw_57
Ld_58:
    v_add_u32 v12, s53, v5
    v_xor_b32 v13, 64, v12
    v_xor_b32 v14, 0x80, v12
    v_xor_b32 v15, 0xc0, v12
    ds_read_b128 v[176:179], v12
    ds_read_b128 v[180:183], v13
    ds_read_b128 v[184:187], v14
    ds_read_b128 v[188:191], v15
    s_add_u32 s51, s51, 16
    s_add_u32 s53, s53, 16384
    s_sub_u32 s54, s53, 151552
    s_cmp_ge_u32 s53, 151552
    s_cselect_b32 s53, s54, s53
    s_waitcnt lgkmcnt(0)
    s_mov_b64 exec, 1
    v_mov_b32 v4, s51
    ds_write_b32 v3, v4
    s_mov_b64 exec, -1
    s_add_u32 s55, s51, 4
    s_cmp_ge_i32 s50, s55
    s_cbranch_scc1 Ld_60
Lw_59:
    ds_read_b32 v4, v2
    s_waitcnt lgkmcnt(0)
    v_readfirstlane_b32 s50, v4
    s_cmp_ge_i32 s50, s55
    s_cbranch_scc1 Ld_60
    s_sub_i32 s69, s69, 1
    s_cmp_gt_i32 s69, 0
    s_cbranch_scc1 Lw_59
Ld_60:
    v_add_u32 v12, s53, v5
    v_xor_b32 v13, 64, v12
    v_xor_b32 v14, 0x80, v12
    v_xor_b32 v15, 0xc0, v12
    ds_read_b128 v[192:195], v12
    ds_read_b128 v[196:199], v13
    ds_read_b128 v[200:203], v14
    ds_read_b128 v[204:207], v15
    s_add_u32 s51, s51, 16
    s_add_u32 s53, s53, 16384
    s_sub_u32 s54, s53, 151552
    s_cmp_ge_u32 s53, 151552
    s_cselect_b32 s53, s54, s53
    s_add_u32 s55, s51, 4
    s_cmp_ge_i32 s50, s55
    s_cbranch_scc1 Ld_62
Lw_61:
    ds_read_b32 v4, v2
    s_waitcnt lgkmcnt(0)
    v_readfirstlane_b32 s50, v4
    s_cmp_ge_i32 s50, s55
    s_cbranch_scc1 Ld_62
    s_sub_i32 s69, s69, 1
    s_cmp_gt_i32 s69, 0
    s_cbranch_scc1 Lw_61
Ld_62:
    v_add_u32 v12, s53, v5
    v_xor_b32 v13, 64, v12
    v_xor_b32 v14, 0x80, v12
    v_xor_b32 v15, 0xc0, v12
    ds_read_b128 v[208:211], v12
    ds_read_b128 v[212:215], v13
    ds_read_b128 v[216:219], v14
    ds_read_b128 v[220:223], v15
    s_add_u32 s51, s51, 16
    s_add_u32 s53, s53, 16384
    s_sub_u32 s54, s53, 151552
    s_cmp_ge_u32 s53, 151552
    s_cselect_b32 s53, s54, s53
    s_waitcnt lgkmcnt(0)
    s_mov_b64 exec, 1
    v_mov_b32 v4, s51
    ds_write_b32 v3, v4
    s_mov_b64 exec, -1
    s_add_u32 s55, s51, 4
    s_cmp_ge_i32 s50, s55
    s_cbranch_scc1 Ld_64
Lw_63:
    ds_read_b32 v4, v2
    s_waitcnt lgkmcnt(0)
    v_readfirstlane_b32 s50, v4
    s_cmp_ge_i32 s50, s55
    s_cbranch_scc1 Ld_64
    s_sub_i32 s69, s69, 1
    s_cmp_gt_i32 s69, 0
    s_cbranch_scc1 Lw_63
Ld_64:
    v_add_u32 v12, s53, v5
    v_xor_b32 v13, 64, v12
    v_xor_b32 v14, 0x80, v12
    v_xor_b32 v15, 0xc0, v12
    ds_read_b128 v[224:227], v12
    ds_read_b128 v[228:231], v13
    ds_read_b128 v[232:235], v14
    ds_read_b128 v[236:239], v15
    s_add_u32 s51, s51, 16
    s_add_u32 s53, s53, 16384
    s_sub_u32 s54, s53, 151552
    s_cmp_ge_u32 s53, 151552
    s_cselect_b32 s53, s54, s53
    s_add_u32 s55, s51, 4
    s_cmp_ge_i32 s50, s55
    s_cbranch_scc1 Ld_66
Lw_65:
    ds_read_b32 v4, v2
    s_waitcnt lgkmcnt(0)
    v_readfirstlane_b32 s50, v4
    s_cmp_ge_i32 s50, s55
    s_cbranch_scc1 Ld_66
    s_sub_i32 s69, s69, 1
    s_cmp_gt_i32 s69, 0
    s_cbranch_scc1 Lw_65
Ld_66:
    v_add_u32 v12, s53, v5
    v_xor_b32 v13, 64, v12
    v_xor_b32 v14, 0x80, v12
    v_xor_b32 v15, 0xc0, v12
    ds_read_b128 v[240:243], v12
    ds_read_b128 v[244:247], v13
    ds_read_b128 v[248:251], v14
    ds_read_b128 v[252:255], v15
    s_add_u32 s51, s51, 16
    s_add_u32 s53, s53, 16384
    s_sub_u32 s54, s53, 151552
    s_cmp_ge_u32 s53, 151552
    s_cselect_b32 s53, s54, s53
    s_waitcnt lgkmcnt(0)
    s_mov_b64 exec, 1
    v_mov_b32 v4, 200
    ds_write_b32 v3, v4
    s_mov_b64 exec, -1
    v_mov_b32 v12, 161400
Lw_67:
    ds_read_b32 v4, v12
    s_waitcnt lgkmcnt(0)
    v_readfirstlane_b32 s54, v4
    s_cmp_ge_i32 s54, 1
    s_cbranch_scc1 Ld_68
    s_sub_i32 s69, s69, 1
    s_cmp_gt_i32 s69, 0
    s_cbranch_scc1 Lw_67
Ld_68:
    v_and_b32 v12, 1, v0
    v_lshlrev_b32 v12, 8, v12
    v_lshl_add_u32 v12, v9, 4, v12
    v_add_u32 v12, 156416, v12
    ds_read_b128 v[32:35], v12
    ds_read_b128 v[36:39], v12 offset:64
    ds_read_b128 v[40:43], v12 offset:128
    ds_read_b128 v[44:47], v12 offset:192
    s_mov_b32 s57, 0x3db504f3
    s_mov_b32 s58, 0x3fb8aa3b
    s_waitcnt lgkmcnt(0)
    v_mfma_f32_16x16x32_bf16 v[48:51], v[128:131], v[32:35], 0
    v_mfma_f32_16x16x32_bf16 v[52:55], v[144:147], v[32:35], 0
    v_mfma_f32_16x16x32_bf16 v[56:59], v[160:163], v[32:35], 0
    v_mfma_f32_16x16x32_bf16 v[60:63], v[176:179], v[32:35], 0
    v_mfma_f32_16x16x32_bf16 v[64:67], v[192:195], v[32:35], 0
    v_mfma_f32_16x16x32_bf16 v[68:71], v[208:211], v[32:35], 0
    v_mfma_f32_16x16x32_bf16 v[72:75], v[224:227], v[32:35], 0
    v_mfma_f32_16x16x32_bf16 v[76:79], v[240:243], v[32:35], 0
    v_mfma_f32_16x16x32_bf16 v[48:51], v[132:135], v[36:39], v[48:51]
    v_mfma_f32_16x16x32_bf16 v[52:55], v[148:151], v[36:39], v[52:55]
    v_mfma_f32_16x16x32_bf16 v[56:59], v[164:167], v[36:39], v[56:59]
    v_mfma_f32_16x16x32_bf16 v[60:63], v[180:183], v[36:39], v[60:63]
    v_mfma_f32_16x16x32_bf16 v[64:67], v[196:199], v[36:39], v[64:67]
    v_mfma_f32_16x16x32_bf16 v[68:71], v[212:215], v[36:39], v[68:71]
    v_mfma_f32_16x16x32_bf16 v[72:75], v[228:231], v[36:39], v[72:75]
    v_mfma_f32_16x16x32_bf16 v[76:79], v[244:247], v[36:39], v[76:79]
    v_mfma_f32_16x16x32_bf16 v[48:51], v[136:139], v[40:43], v[48:51]
    v_mfma_f32_16x16x32_bf16 v[52:55], v[152:155], v[40:43], v[52:55]
    v_mfma_f32_16x16x32_bf16 v[56:59], v[168:171], v[40:43], v[56:59]
    v_mfma_f32_16x16x32_bf16 v[60:63], v[184:187], v[40:43], v[60:63]
    v_mfma_f32_16x16x32_bf16 v[64:67], v[200:203], v[40:43], v[64:67]
    v_mfma_f32_16x16x32_bf16 v[68:71], v[216:219], v[40:43], v[68:71]
    v_mfma_f32_16x16x32_bf16 v[72:75], v[232:235], v[40:43], v[72:75]
    v_mfma_f32_16x16x32_bf16 v[76:79], v[248:251], v[40:43], v[76:79]
    v_mfma_f32_16x16x32_bf16 v[48:51], v[140:143], v[44:47], v[48:51]
    v_mfma_f32_16x16x32_bf16 v[52:55], v[156:159], v[44:47], v[52:55]
    v_mfma_f32_16x16x32_bf16 v[56:59], v[172:175], v[44:47], v[56:59]
    v_mfma_f32_16x16x32_bf16 v[60:63], v[188:191], v[44:47], v[60:63]
    v_mfma_f32_16x16x32_bf16 v[64:67], v[204:207], v[44:47], v[64:67]
    v_mfma_f32_16x16x32_bf16 v[68:71], v[220:223], v[44:47], v[68:71]
    v_mfma_f32_16x16x32_bf16 v[72:75], v[236:239], v[44:47], v[72:75]
    v_mfma_f32_16x16x32_bf16 v[76:79], v[252:255], v[44:47], v[76:79]
    s_nop 1
    v_cvt_pk_bf16_f32 v12, v48, v49
    v_lshlrev_b32 v48, 16, v12
    v_and_b32 v49, s56, v12
    v_mul_f32 v48, s57, v48
    v_mul_f32 v49, s57, v49
    v_cvt_pk_bf16_f32 v12, v48, v49
    v_lshlrev_b32 v48, 16, v12
    v_and_b32 v49, s56, v12
    v_cvt_pk_bf16_f32 v12, v50, v51
    v_lshlrev_b32 v50, 16, v12
    v_and_b32 v51, s56, v12
    v_mul_f32 v50, s57, v50
    v_mul_f32 v51, s57, v51
    v_cvt_pk_bf16_f32 v12, v50, v51
    v_lshlrev_b32 v50, 16, v12
    v_and_b32 v51, s56, v12
    v_cvt_pk_bf16_f32 v12, v52, v53
    v_lshlrev_b32 v52, 16, v12
    v_and_b32 v53, s56, v12
    v_mul_f32 v52, s57, v52
    v_mul_f32 v53, s57, v53
    v_cvt_pk_bf16_f32 v12, v52, v53
    v_lshlrev_b32 v52, 16, v12
    v_and_b32 v53, s56, v12
    v_cvt_pk_bf16_f32 v12, v54, v55
    v_lshlrev_b32 v54, 16, v12
    v_and_b32 v55, s56, v12
    v_mul_f32 v54, s57, v54
    v_mul_f32 v55, s57, v55
    v_cvt_pk_bf16_f32 v12, v54, v55
    v_lshlrev_b32 v54, 16, v12
    v_and_b32 v55, s56, v12
    v_cvt_pk_bf16_f32 v12, v56, v57
    v_lshlrev_b32 v56, 16, v12
    v_and_b32 v57, s56, v12
    v_mul_f32 v56, s57, v56
    v_mul_f32 v57, s57, v57
    v_cvt_pk_bf16_f32 v12, v56, v57
    v_lshlrev_b32 v56, 16, v12
    v_and_b32 v57, s56, v12
    v_cvt_pk_bf16_f32 v12, v58, v59
    v_lshlrev_b32 v58, 16, v12
    v_and_b32 v59, s56, v12
    v_mul_f32 v58, s57, v58
    v_mul_f32 v59, s57, v59
    v_cvt_pk_bf16_f32 v12, v58, v59
    v_lshlrev_b32 v58, 16, v12
    v_and_b32 v59, s56, v12
    v_cvt_pk_bf16_f32 v12, v60, v61
    v_lshlrev_b32 v60, 16, v12
    v_and_b32 v61, s56, v12
    v_mul_f32 v60, s57, v60
    v_mul_f32 v61, s57, v61
    v_cvt_pk_bf16_f32 v12, v60, v61
    v_lshlrev_b32 v60, 16, v12
    v_and_b32 v61, s56, v12
    v_cvt_pk_bf16_f32 v12, v62, v63
    v_lshlrev_b32 v62, 16, v12
    v_and_b32 v63, s56, v12
    v_mul_f32 v62, s57, v62
    v_mul_f32 v63, s57, v63
    v_cvt_pk_bf16_f32 v12, v62, v63
    v_lshlrev_b32 v62, 16, v12
    v_and_b32 v63, s56, v12
    v_cvt_pk_bf16_f32 v12, v64, v65
    v_lshlrev_b32 v64, 16, v12
    v_and_b32 v65, s56, v12
    v_mul_f32 v64, s57, v64
    v_mul_f32 v65, s57, v65
    v_cvt_pk_bf16_f32 v12, v64, v65
    v_lshlrev_b32 v64, 16, v12
    v_and_b32 v65, s56, v12
    v_cvt_pk_bf16_f32 v12, v66, v67
    v_lshlrev_b32 v66, 16, v12
    v_and_b32 v67, s56, v12
    v_mul_f32 v66, s57, v66
    v_mul_f32 v67, s57, v67
    v_cvt_pk_bf16_f32 v12, v66, v67
    v_lshlrev_b32 v66, 16, v12
    v_and_b32 v67, s56, v12
    v_cvt_pk_bf16_f32 v12, v68, v69
    v_lshlrev_b32 v68, 16, v12
    v_and_b32 v69, s56, v12
    v_mul_f32 v68, s57, v68
    v_mul_f32 v69, s57, v69
    v_cvt_pk_bf16_f32 v12, v68, v69
    v_lshlrev_b32 v68, 16, v12
    v_and_b32 v69, s56, v12
    v_cvt_pk_bf16_f32 v12, v70, v71
    v_lshlrev_b32 v70, 16, v12
    v_and_b32 v71, s56, v12
    v_mul_f32 v70, s57, v70
    v_mul_f32 v71, s57, v71
    v_cvt_pk_bf16_f32 v12, v70, v71
    v_lshlrev_b32 v70, 16, v12
    v_and_b32 v71, s56, v12
    v_cvt_pk_bf16_f32 v12, v72, v73
    v_lshlrev_b32 v72, 16, v12
    v_and_b32 v73, s56, v12
    v_mul_f32 v72, s57, v72
    v_mul_f32 v73, s57, v73
    v_cvt_pk_bf16_f32 v12, v72, v73
    v_lshlrev_b32 v72, 16, v12
    v_and_b32 v73, s56, v12
    v_cvt_pk_bf16_f32 v12, v74, v75
    v_lshlrev_b32 v74, 16, v12
    v_and_b32 v75, s56, v12
    v_mul_f32 v74, s57, v74
    v_mul_f32 v75, s57, v75
    v_cvt_pk_bf16_f32 v12, v74, v75
    v_lshlrev_b32 v74, 16, v12
    v_and_b32 v75, s56, v12
    v_cvt_pk_bf16_f32 v12, v76, v77
    v_lshlrev_b32 v76, 16, v12
    v_and_b32 v77, s56, v12
    v_mul_f32 v76, s57, v76
    v_mul_f32 v77, s57, v77
    v_cvt_pk_bf16_f32 v12, v76, v77
    v_lshlrev_b32 v76, 16, v12
    v_and_b32 v77, s56, v12
    v_cvt_pk_bf16_f32 v12, v78, v79
    v_lshlrev_b32 v78, 16, v12
    v_and_b32 v79, s56, v12
    v_mul_f32 v78, s57, v78
    v_mul_f32 v79, s57, v79
    v_cvt_pk_bf16_f32 v12, v78, v79
    v_lshlrev_b32 v78, 16, v12
    v_and_b32 v79, s56, v12
    v_max3_f32 v12, v48, v49, v50
    v_max3_f32 v12, v12, v51, v52
    v_max3_f32 v12, v12, v53, v54
    v_max3_f32 v12, v12, v55, v56
    v_max3_f32 v12, v12, v57, v58
    v_max3_f32 v12, v12, v59, v60
    v_max3_f32 v12, v12, v61, v62
    v_max3_f32 v12, v12, v63, v64
    v_max3_f32 v12, v12, v65, v66
    v_max3_f32 v12, v12, v67, v68
    v_max3_f32 v12, v12, v69, v70
    v_max3_f32 v12, v12, v71, v72
    v_max3_f32 v12, v12, v73, v74
    v_max3_f32 v12, v12, v75, v76
    v_max3_f32 v12, v12, v77, v78
    v_max_f32 v12, v12, v79
    v_mov_b32 v13, v12
    s_nop 1
    v_permlane16_swap_b32 v12, v13
    s_nop 0
    v_max_f32 v12, v12, v13
    v_mov_b32 v13, v12
    s_nop 1
    v_permlane32_swap_b32 v12, v13
    s_nop 0
    v_max_f32 v12, v12, v13
    v_and_b32 v14, 1, v0
    v_lshlrev_b32 v14, 4, v14
    v_add_u32 v14, 161360, v14
    s_lshl_b32 s54, s36, 2
    v_add_u32 v15, s54, v14
    v_mov_b32 v16, 161432
    v_mov_b32 v17, 1
    s_mov_b64 exec, 3
    ds_write_b32 v15, v12
    s_mov_b64 exec, 1
    ds_add_u32 v16, v17
    s_mov_b64 exec, -1
Lw_69:
    ds_read_b32 v4, v16
    s_waitcnt lgkmcnt(0)
    v_readfirstlane_b32 s54, v4
    s_cmp_ge_i32 s54, 4
    s_cbranch_scc1 Ld_70
    s_sub_i32 s69, s69, 1
    s_cmp_gt_i32 s69, 0
    s_cbranch_scc1 Lw_69
Ld_70:
    ds_read_b128 v[16:19], v14
    s_waitcnt lgkmcnt(0)
    v_max3_f32 v12, v16, v17, v18
    v_max_f32 v12, v12, v19
    v_sub_f32 v48, v48, v12
    v_sub_f32 v49, v49, v12
    v_sub_f32 v50, v50, v12
    v_sub_f32 v51, v51, v12
    v_sub_f32 v52, v52, v12
    v_sub_f32 v53, v53, v12
    v_sub_f32 v54, v54, v12
    v_sub_f32 v55, v55, v12
    v_sub_f32 v56, v56, v12
    v_sub_f32 v57, v57, v12
    v_sub_f32 v58, v58, v12
    v_sub_f32 v59, v59, v12
    v_sub_f32 v60, v60, v12
    v_sub_f32 v61, v61, v12
    v_sub_f32 v62, v62, v12
    v_sub_f32 v63, v63, v12
    v_sub_f32 v64, v64, v12
    v_sub_f32 v65, v65, v12
    v_sub_f32 v66, v66, v12
    v_sub_f32 v67, v67, v12
    v_sub_f32 v68, v68, v12
    v_sub_f32 v69, v69, v12
    v_sub_f32 v70, v70, v12
    v_sub_f32 v71, v71, v12
    v_sub_f32 v72, v72, v12
    v_sub_f32 v73, v73, v12
    v_sub_f32 v74, v74, v12
    v_sub_f32 v75, v75, v12
    v_sub_f32 v76, v76, v12
    v_sub_f32 v77, v77, v12
    v_sub_f32 v78, v78, v12
    v_sub_f32 v79, v79, v12
    v_mul_f32 v48, s58, v48
    v_mul_f32 v49, s58, v49
    v_mul_f32 v50, s58, v50
    v_mul_f32 v51, s58, v51
    v_mul_f32 v52, s58, v52
    v_mul_f32 v53, s58, v53
    v_mul_f32 v54, s58, v54
    v_mul_f32 v55, s58, v55
    v_mul_f32 v56, s58, v56
    v_mul_f32 v57, s58, v57
    v_mul_f32 v58, s58, v58
    v_mul_f32 v59, s58, v59
    v_mul_f32 v60, s58, v60
    v_mul_f32 v61, s58, v61
    v_mul_f32 v62, s58, v62
    v_mul_f32 v63, s58, v63
    v_mul_f32 v64, s58, v64
    v_mul_f32 v65, s58, v65
    v_mul_f32 v66, s58, v66
    v_mul_f32 v67, s58, v67
    v_mul_f32 v68, s58, v68
    v_mul_f32 v69, s58, v69
    v_mul_f32 v70, s58, v70
    v_mul_f32 v71, s58, v71
    v_mul_f32 v72, s58, v72
    v_mul_f32 v73, s58, v73
    v_mul_f32 v74, s58, v74
    v_mul_f32 v75, s58, v75
    v_mul_f32 v76, s58, v76
    v_mul_f32 v77, s58, v77
    v_mul_f32 v78, s58, v78
    v_mul_f32 v79, s58, v79
    v_exp_f32 v48, v48
    v_exp_f32 v49, v49
    v_exp_f32 v50, v50
    v_exp_f32 v51, v51
    v_exp_f32 v52, v52
    v_exp_f32 v53, v53
    v_exp_f32 v54, v54
    v_exp_f32 v55, v55
    v_exp_f32 v56, v56
    v_exp_f32 v57, v57
    v_exp_f32 v58, v58
    v_exp_f32 v59, v59
    v_exp_f32 v60, v60
    v_exp_f32 v61, v61
    v_exp_f32 v62, v62
    v_exp_f32 v63, v63
    v_exp_f32 v64, v64
    v_exp_f32 v65, v65
    v_exp_f32 v66, v66
    v_exp_f32 v67, v67
    v_exp_f32 v68, v68
    v_exp_f32 v69, v69
    v_exp_f32 v70, v70
    v_exp_f32 v71, v71
    v_exp_f32 v72, v72
    v_exp_f32 v73, v73
    v_exp_f32 v74, v74
    v_exp_f32 v75, v75
    v_exp_f32 v76, v76
    v_exp_f32 v77, v77
    v_exp_f32 v78, v78
    v_exp_f32 v79, v79
    v_add_f32 v13, v48, v49
    v_add_f32 v14, v50, v51
    v_add_f32 v13, v13, v52
    v_add_f32 v14, v14, v53
    v_add_f32 v13, v13, v54
    v_add_f32 v14, v14, v55
    v_add_f32 v13, v13, v56
    v_add_f32 v14, v14, v57
    v_add_f32 v13, v13, v58
    v_add_f32 v14, v14, v59
    v_add_f32 v13, v13, v60
    v_add_f32 v14, v14, v61
    v_add_f32 v13, v13, v62
    v_add_f32 v14, v14, v63
    v_add_f32 v13, v13, v64
    v_add_f32 v14, v14, v65
    v_add_f32 v13, v13, v66
    v_add_f32 v14, v14, v67
    v_add_f32 v13, v13, v68
    v_add_f32 v14, v14, v69
    v_add_f32 v13, v13, v70
    v_add_f32 v14, v14, v71
    v_add_f32 v13, v13, v72
    v_add_f32 v14, v14, v73
    v_add_f32 v13, v13, v74
    v_add_f32 v14, v14, v75
    v_add_f32 v13, v13, v76
    v_add_f32 v14, v14, v77
    v_add_f32 v13, v13, v78
    v_add_f32 v14, v14, v79
    v_cvt_pk_bf16_f32 v80, v48, v49
    v_cvt_pk_bf16_f32 v81, v50, v51
    v_cvt_pk_bf16_f32 v82, v52, v53
    v_cvt_pk_bf16_f32 v83, v54, v55
    v_cvt_pk_bf16_f32 v84, v56, v57
    v_cvt_pk_bf16_f32 v85, v58, v59
    v_cvt_pk_bf16_f32 v86, v60, v61
    v_cvt_pk_bf16_f32 v87, v62, v63
    v_cvt_pk_bf16_f32 v88, v64, v65
    v_cvt_pk_bf16_f32 v89, v66, v67
    v_cvt_pk_bf16_f32 v90, v68, v69
    v_cvt_pk_bf16_f32 v91, v70, v71
    v_cvt_pk_bf16_f32 v92, v72, v73
    v_cvt_pk_bf16_f32 v93, v74, v75
    v_cvt_pk_bf16_f32 v94, v76, v77
    v_cvt_pk_bf16_f32 v95, v78, v79
    v_add_f32 v13, v13, v14
    v_mov_b32 v14, v13
    s_nop 1
    v_permlane16_swap_b32 v13, v14
    s_nop 0
    v_add_f32 v13, v13, v14
    v_mov_b32 v14, v13
    s_nop 1
    v_permlane32_swap_b32 v13, v14
    s_nop 0
    v_add_f32 v13, v13, v14
    s_lshl_b32 s54, s36, 4
    s_add_u32 s54, s54, 161296
    v_lshlrev_b32 v14, 3, v0
    v_add_u32 v14, s54, v14
    v_and_b32 v15, 1, v0
    v_lshlrev_b32 v15, 6, v15
    v_lshl_add_u32 v15, v9, 4, v15
    v_add_u32 v31, 156928, v15
    s_lshr_b32 s54, s36, 1
    s_lshl_b32 s54, s54, 7
    s_and_b32 s55, s36, 1
    s_lshl_b32 s55, s55, 3
    s_add_u32 s54, s54, s55
    v_add_u32 v15, s54, v31
    s_mov_b64 exec, 3
    ds_write_b64 v14, v[12:13]
    s_mov_b32 exec_lo, 0x00030003
    s_mov_b32 exec_hi, 0x00030003
    ds_write_b64 v15, v[80:81] offset:0
    ds_write_b64 v15, v[82:83] offset:256
    ds_write_b64 v15, v[84:85] offset:512
    ds_write_b64 v15, v[86:87] offset:768
    ds_write_b64 v15, v[88:89] offset:1024
    ds_write_b64 v15, v[90:91] offset:1280
    ds_write_b64 v15, v[92:93] offset:1536
    ds_write_b64 v15, v[94:95] offset:1792
    s_mov_b64 exec, 1
    v_mov_b32 v30, 161392
    v_mov_b32 v15, 1
    ds_add_u32 v30, v15
    s_mov_b64 exec, -1
    s_sub_u32 s38, s31, 8
    s_cmp_ge_u32 s38, 9
    s_cselect_b32 s37, 1, 0
    s_cselect_b32 s39, 9, 0
    s_sub_u32 s38, s38, s39
    s_cmp_ge_u32 s31, 26
    s_cbranch_scc0 Lt_71
    s_sub_u32 s38, s31, 26
    s_cmp_ge_u32 s38, 3
    s_cselect_b32 s37, 17, 16
    s_cselect_b32 s39, 3, 0
    s_sub_u32 s38, s38, s39
Lt_71:
    s_lshl_b32 s39, s30, 1
    s_add_u32 s37, s37, s39
    v_mov_b32 v26, 1
    v_lshlrev_b32 v29, 2, v0
    s_lshl_b32 s49, s33, 2
    s_add_u32 s49, s49, s35
    s_lshl_b32 s49, s49, 10
    s_lshl_b32 s54, s36, 8
    s_add_u32 s49, s49, s54
    s_add_u32 s49, s49, 122880
    v_and_b32 v24, 1, v9
    v_cmp_eq_u32 s[4:5], 1, v24
    v_lshrrev_b32 v25, 1, v9
    v_cmp_eq_u32 s[6:7], 1, v25
    s_lshl_b32 s54, s36, 6
    v_xor_b32 v6, s54, v6
    s_mov_b32 s53, 53248
    s_mov_b32 s55, 208
    v_mov_b32 v96, 0
    v_mov_b32 v97, 0
    v_mov_b32 v98, 0
    v_mov_b32 v99, 0
    v_mov_b32 v100, 0
    v_mov_b32 v101, 0
    v_mov_b32 v102, 0
    v_mov_b32 v103, 0
Lw_72:
    ds_read_b32 v4, v30
    s_waitcnt lgkmcnt(0)
    v_readfirstlane_b32 s54, v4
    s_cmp_ge_i32 s54, 4
    s_cbranch_scc1 Ld_73
    s_sub_i32 s69, s69, 1
    s_cmp_gt_i32 s69, 0
    s_cbranch_scc1 Lw_72
Ld_73:
Lpv_74:
    v_add_u32 v12, s53, v6
    v_xor_b32 v13, 32, v12
    ds_read_b128 v[32:35], v31
    s_cmp_ge_i32 s50, s55
    s_cbranch_scc1 Ld_76
Lw_75:
    ds_read_b32 v4, v2
    s_waitcnt lgkmcnt(0)
    v_readfirstlane_b32 s50, v4
    s_cmp_ge_i32 s50, s55
    s_cbranch_scc1 Ld_76
    s_sub_i32 s69, s69, 1
    s_cmp_gt_i32 s69, 0
    s_cbranch_scc1 Lw_75
Ld_76:
    ds_read_b64_tr_b16 v[128:129], v12
    ds_read_b64_tr_b16 v[130:131], v12 offset:4096
    ds_read_b64_tr_b16 v[132:133], v13
    ds_read_b64_tr_b16 v[134:135], v13 offset:4096
    v_add_u32 v31, 128, v31
    s_add_u32 s53, s53, 8192
    s_cmp_eq_u32 s53, 151552
    s_cselect_b32 s53, 0, s53
    s_cmp_eq_u32 s55, 328
    s_waitcnt lgkmcnt(2)
    v_mfma_f32_16x16x32_bf16 v[96:99], v[32:35], v[128:131], v[96:99]
    s_waitcnt lgkmcnt(0)
    v_mfma_f32_16x16x32_bf16 v[100:103], v[32:35], v[132:135], v[100:103]
    s_cbranch_scc1 L_cs_pvd
    s_mov_b64 exec, 1
    v_mov_b32 v4, s55
    ds_write_b32 v3, v4
    s_mov_b64 exec, -1
    s_add_u32 s55, s55, 8
    s_branch Lpv_74
L_cs_pvd:
    s_nop 5
    v_cndmask_b32 v104, v96, v97, s[6:7]
    s_nop 0
    v_cndmask_b32 v105, v100, v101, s[6:7]
    v_cndmask_b32 v104, v104, v105, s[4:5]
    buffer_store_dword v104, v29, s[40:43], s49 offen sc1
    s_mov_b64 exec, 1
    v_mov_b32 v4, 328
    ds_write_b32 v3, v4
    s_mov_b64 exec, -1
L_cs_nolast:
    s_cmp_lt_u32 s31, 8
    s_cbranch_scc1 L_cs_red
    s_cmp_ge_u32 s31, 26
    s_cbranch_scc1 L_cs_down
    v_lshlrev_b32 v20, 16, v9
    v_lshl_add_u32 v20, v8, 4, v20
    v_and_b32 v16, 8, v0
    v_lshl_add_u32 v20, v16, 4, v20
    s_lshl_b32 s46, s37, 12
    s_and_b32 s47, s36, 1
    s_lshl_b32 s47, s47, 9
    s_add_u32 s46, s46, s47
    s_lshr_b32 s47, s36, 1
    s_lshl_b32 s47, s47, 7
    s_add_u32 s46, s46, s47
    s_add_u32 s46, s46, 122880
    s_lshl_b32 s54, s36, 5
    v_xor_b32 v12, s54, v7
    v_add_u32 v12, 32768, v12
    v_mov_b32 v25, 161412
    s_mul_i32 s44, s37, 9216
    s_lshl_b32 s45, s38, 10
    s_add_u32 s44, s44, s45
    s_lshl_b32 s45, s36, 8
    s_add_u32 s44, s44, s45
    s_add_u32 s44, s44, 385024
    s_lshl_b32 s54, s36, 9
    s_add_u32 s54, s54, 161536
    v_lshlrev_b32 v21, 7, v9
    v_bfe_u32 v16, v0, 3, 1
    v_lshl_add_u32 v21, v16, 6, v21
    v_lshl_add_u32 v21, v11, 4, v21
    v_bfe_u32 v16, v0, 2, 1
    v_lshl_add_u32 v21, v16, 3, v21
    v_add_u32 v21, s54, v21
    v_lshlrev_b32 v23, 7, v11
    v_lshl_add_u32 v23, v9, 4, v23
    v_add_u32 v23, 161536, v23
    v_lshlrev_b32 v16, 5, v9
    v_lshl_add_u32 v16, v11, 3, v16
    s_lshr_b32 s47, s36, 1
    s_lshl_b32 s47, s47, 2
    s_add_u32 s47, s47, 156416
    v_add_u32 v16, s47, v16
    v_mov_b32 v17, 161428
Lw_77:
    ds_read_b32 v4, v17
    s_waitcnt lgkmcnt(0)
    v_readfirstlane_b32 s47, v4
    s_cmp_ge_i32 s47, 1
    s_cbranch_scc1 Ld_78
    s_sub_i32 s69, s69, 1
    s_cmp_gt_i32 s69, 0
    s_cbranch_scc1 Lw_77
Ld_78:
    ds_read_b32 v234, v16
    s_waitcnt lgkmcnt(0)
    s_cmp_ge_i32 s50, 352
    s_cbranch_scc1 Ld_80
Lw_79:
    ds_read_b32 v4, v2
    s_waitcnt lgkmcnt(0)
    v_readfirstlane_b32 s50, v4
    s_cmp_ge_i32 s50, 352
    s_cbranch_scc1 Ld_80
    s_sub_i32 s69, s69, 1
    s_cmp_gt_i32 s69, 0
    s_cbranch_scc1 Lw_79
Ld_80:
    buffer_load_dwordx4 v[216:219], v20, s[40:43], s46 offen offset:0 sc1
    buffer_load_dwordx4 v[220:223], v20, s[40:43], s46 offen offset:1024 sc1
    buffer_load_dwordx4 v[224:227], v20, s[40:43], s46 offen offset:2048 sc1
    buffer_load_dwordx4 v[228:231], v20, s[40:43], s46 offen offset:3072 sc1
    s_cmp_ge_i32 s50, 352
    s_cbranch_scc1 Ld_82
Lw_81:
    ds_read_b32 v4, v2
    s_waitcnt lgkmcnt(0)
    v_readfirstlane_b32 s50, v4
    s_cmp_ge_i32 s50, 352
    s_cbranch_scc1 Ld_82
    s_sub_i32 s69, s69, 1
    s_cmp_gt_i32 s69, 0
    s_cbranch_scc1 Lw_81
Ld_82:
    ds_read_b64_tr_b16 v[128:129], v12 offset:0
    ds_read_b64_tr_b16 v[130:131], v12 offset:2048
    ds_read_b64_tr_b16 v[132:133], v12 offset:4096
    ds_read_b64_tr_b16 v[134:135], v12 offset:6144
    ds_read_b64_tr_b16 v[136:137], v12 offset:8192
    ds_read_b64_tr_b16 v[138:139], v12 offset:10240
    ds_read_b64_tr_b16 v[140:141], v12 offset:12288
    ds_read_b64_tr_b16 v[142:143], v12 offset:14336
    ds_read_b64_tr_b16 v[144:145], v12 offset:16384
    ds_read_b64_tr_b16 v[146:147], v12 offset:18432
    ds_read_b64_tr_b16 v[148:149], v12 offset:20480
    ds_read_b64_tr_b16 v[150:151], v12 offset:22528
    s_cmp_ge_i32 s50, 356
    s_cbranch_scc1 Ld_84
Lw_83:
    ds_read_b32 v4, v2
    s_waitcnt lgkmcnt(0)
    v_readfirstlane_b32 s50, v4
    s_cmp_ge_i32 s50, 356
    s_cbranch_scc1 Ld_84
    s_sub_i32 s69, s69, 1
    s_cmp_gt_i32 s69, 0
    s_cbranch_scc1 Lw_83
Ld_84:
    ds_read_b64_tr_b16 v[152:153], v12 offset:24576
    ds_read_b64_tr_b16 v[154:155], v12 offset:26624
    s_cmp_ge_i32 s50, 360
    s_cbranch_scc1 Ld_86
Lw_85:
    ds_read_b32 v4, v2
    s_waitcnt lgkmcnt(0)
    v_readfirstlane_b32 s50, v4
    s_cmp_ge_i32 s50, 360
    s_cbranch_scc1 Ld_86
    s_sub_i32 s69, s69, 1
    s_cmp_gt_i32 s69, 0
    s_cbranch_scc1 Lw_85
Ld_86:
    ds_read_b64_tr_b16 v[156:157], v12 offset:28672
    ds_read_b64_tr_b16 v[158:159], v12 offset:30720
    s_mov_b32 s59, 65536
    s_waitcnt vmcnt(0)
    v_max3_u32 v36, v216, v217, v218
    v_max3_u32 v37, v219, v220, v221
    v_max3_u32 v36, v36, v222, v223
    v_max3_u32 v37, v37, v224, v225
    v_max3_u32 v36, v36, v226, v227
    v_max3_u32 v37, v37, v228, v229
    v_max3_u32 v36, v36, v230, v231
    v_max_u32 v36, v36, v37
    v_cmp_eq_u32 vcc, -1, v36
    s_cbranch_vccz Lgod_88
    s_mov_b64 exec, vcc
Lgo_87:
    s_sleep 2
    buffer_load_dwordx4 v[216:219], v20, s[40:43], s46 offen offset:0 sc1
    buffer_load_dwordx4 v[220:223], v20, s[40:43], s46 offen offset:1024 sc1
    buffer_load_dwordx4 v[224:227], v20, s[40:43], s46 offen offset:2048 sc1
    buffer_load_dwordx4 v[228:231], v20, s[40:43], s46 offen offset:3072 sc1
    s_mov_b64 exec, -1
    s_waitcnt vmcnt(0)
    v_max3_u32 v36, v216, v217, v218
    v_max3_u32 v37, v219, v220, v221
    v_max3_u32 v36, v36, v222, v223
    v_max3_u32 v37, v37, v224, v225
    v_max3_u32 v36, v36, v226, v227
    v_max3_u32 v37, v37, v228, v229
    v_max3_u32 v36, v36, v230, v231
    v_max_u32 v36, v36, v37
    v_cmp_eq_u32 vcc, -1, v36
    s_cbranch_vccz Lgod_88
    s_mov_b64 exec, vcc
    s_sub_u32 s59, s59, 1
    s_cmp_lg_u32 s59, 0
    s_cbranch_scc1 Lgo_87
    s_mov_b64 exec, -1
Lgod_88:
    v_mul_f32_dpp v240, v234, v216 quad_perm:[0,0,0,0] row_mask:0xf bank_mask:0xf
    v_mul_f32_dpp v241, v234, v217 quad_perm:[0,0,0,0] row_mask:0xf bank_mask:0xf
    v_mul_f32_dpp v242, v234, v218 quad_perm:[0,0,0,0] row_mask:0xf bank_mask:0xf
    v_mul_f32_dpp v243, v234, v219 quad_perm:[0,0,0,0] row_mask:0xf bank_mask:0xf
    v_fmac_f32_dpp v240, v234, v220 quad_perm:[1,1,1,1] row_mask:0xf bank_mask:0xf
    v_fmac_f32_dpp v241, v234, v221 quad_perm:[1,1,1,1] row_mask:0xf bank_mask:0xf
    v_fmac_f32_dpp v242, v234, v222 quad_perm:[1,1,1,1] row_mask:0xf bank_mask:0xf
    v_fmac_f32_dpp v243, v234, v223 quad_perm:[1,1,1,1] row_mask:0xf bank_mask:0xf
    v_fmac_f32_dpp v240, v234, v224 quad_perm:[2,2,2,2] row_mask:0xf bank_mask:0xf
    v_fmac_f32_dpp v241, v234, v225 quad_perm:[2,2,2,2] row_mask:0xf bank_mask:0xf
    v_fmac_f32_dpp v242, v234, v226 quad_perm:[2,2,2,2] row_mask:0xf bank_mask:0xf
    v_fmac_f32_dpp v243, v234, v227 quad_perm:[2,2,2,2] row_mask:0xf bank_mask:0xf
    v_fmac_f32_dpp v240, v234, v228 quad_perm:[3,3,3,3] row_mask:0xf bank_mask:0xf
    v_fmac_f32_dpp v241, v234, v229 quad_perm:[3,3,3,3] row_mask:0xf bank_mask:0xf
    v_fmac_f32_dpp v242, v234, v230 quad_perm:[3,3,3,3] row_mask:0xf bank_mask:0xf
    v_fmac_f32_dpp v243, v234, v231 quad_perm:[3,3,3,3] row_mask:0xf bank_mask:0xf
    v_cvt_pk_bf16_f32 v244, v240, v241
    v_cvt_pk_bf16_f32 v245, v242, v243
    ds_write_b64 v21, v[244:245]
    s_mov_b64 exec, 1
    ds_add_u32 v25, v26
    s_mov_b64 exec, -1
Lw_89:
    ds_read_b32 v4, v25
    s_waitcnt lgkmcnt(0)
    v_readfirstlane_b32 s54, v4
    s_cmp_ge_i32 s54, 4
    s_cbranch_scc1 Ld_90
    s_sub_i32 s69, s69, 1
    s_cmp_gt_i32 s69, 0
    s_cbranch_scc1 Lw_89
Ld_90:
    ds_read_b128 v[160:163], v23 offset:0
    ds_read_b128 v[164:167], v23 offset:64
    ds_read_b128 v[168:171], v23 offset:512
    ds_read_b128 v[172:175], v23 offset:576
    ds_read_b128 v[176:179], v23 offset:1024
    ds_read_b128 v[180:183], v23 offset:1088
    ds_read_b128 v[184:187], v23 offset:1536
    ds_read_b128 v[188:191], v23 offset:1600
    s_waitcnt lgkmcnt(7)
    v_mfma_f32_16x16x32_bf16 v[240:243], v[160:163], v[128:131], 0
    s_waitcnt lgkmcnt(6)
    v_mfma_f32_16x16x32_bf16 v[240:243], v[164:167], v[132:135], v[240:243]
    s_waitcnt lgkmcnt(5)
    v_mfma_f32_16x16x32_bf16 v[240:243], v[168:171], v[136:139], v[240:243]
    s_waitcnt lgkmcnt(4)
    v_mfma_f32_16x16x32_bf16 v[240:243], v[172:175], v[140:143], v[240:243]
    s_waitcnt lgkmcnt(3)
    v_mfma_f32_16x16x32_bf16 v[240:243], v[176:179], v[144:147], v[240:243]
    s_waitcnt lgkmcnt(2)
    v_mfma_f32_16x16x32_bf16 v[240:243], v[180:183], v[148:151], v[240:243]
    s_waitcnt lgkmcnt(1)
    v_mfma_f32_16x16x32_bf16 v[240:243], v[184:187], v[152:155], v[240:243]
    s_waitcnt lgkmcnt(0)
    v_mfma_f32_16x16x32_bf16 v[240:243], v[188:191], v[156:159], v[240:243]
    s_nop 7
    v_cndmask_b32 v244, v240, v241, s[4:5]
    v_cndmask_b32 v245, v242, v243, s[4:5]
    v_cndmask_b32 v244, v244, v245, s[6:7]
    buffer_store_dword v244, v29, s[40:43], s44 offen sc1
    s_branch L_cs_end
L_cs_down:
    v_bfe_u32 v13, v0, 3, 2
    v_mul_u32_u24 v14, 384, v10
    v_lshl_add_u32 v14, v11, 3, v14
    v_add_u32 v14, 32768, v14
    s_mul_i32 s54, s36, 3
    v_xor_b32 v16, s54, v13
    v_lshl_add_u32 v16, v16, 5, v14
    s_add_u32 s54, s54, 1
    v_xor_b32 v17, s54, v13
    v_lshl_add_u32 v17, v17, 5, v14
    s_add_u32 s54, s54, 1
    v_xor_b32 v18, s54, v13
    v_lshl_add_u32 v18, v18, 5, v14
    s_mul_i32 s44, s37, 9216
    s_mul_i32 s45, s38, 3072
    s_add_u32 s44, s44, s45
    s_mul_i32 s45, s36, 768
    s_add_u32 s44, s44, s45
    s_add_u32 s44, s44, 385024
    v_mov_b32 v12, 161404
Lw_91:
    ds_read_b32 v4, v12
    s_waitcnt lgkmcnt(0)
    v_readfirstlane_b32 s54, v4
    s_cmp_ge_i32 s54, 1
    s_cbranch_scc1 Ld_92
    s_sub_i32 s69, s69, 1
    s_cmp_gt_i32 s69, 0
    s_cbranch_scc1 Lw_91
Ld_92:
    v_mul_u32_u24 v20, 576, v11
    v_lshl_add_u32 v20, v9, 4, v20
    v_add_u32 v20, 151552, v20
    s_mov_b32 s51, 340
    v_mov_b32 v240, 0
    v_mov_b32 v241, 0
    v_mov_b32 v242, 0
    v_mov_b32 v243, 0
    v_mov_b32 v244, 0
    v_mov_b32 v245, 0
    v_mov_b32 v246, 0
    v_mov_b32 v247, 0
    v_mov_b32 v248, 0
    v_mov_b32 v249, 0
    v_mov_b32 v250, 0
    v_mov_b32 v251, 0
Ldn_93:
    s_cmp_ge_i32 s50, s51
    s_cbranch_scc1 Ld_95
Lw_94:
    ds_read_b32 v4, v2
    s_waitcnt lgkmcnt(0)
    v_readfirstlane_b32 s50, v4
    s_cmp_ge_i32 s50, s51
    s_cbranch_scc1 Ld_95
    s_sub_i32 s69, s69, 1
    s_cmp_gt_i32 s69, 0
    s_cbranch_scc1 Lw_94
Ld_95:
    ds_read_b128 v[232:235], v20
    ds_read_b64_tr_b16 v[192:193], v16
    ds_read_b64_tr_b16 v[194:195], v16 offset:6144
    ds_read_b64_tr_b16 v[196:197], v17
    ds_read_b64_tr_b16 v[198:199], v17 offset:6144
    ds_read_b64_tr_b16 v[200:201], v18
    ds_read_b64_tr_b16 v[202:203], v18 offset:6144
    v_add_u32 v20, 64, v20
    v_add_u32 v16, 12288, v16
    v_add_u32 v17, 12288, v17
    v_add_u32 v18, 12288, v18
    s_add_u32 s51, s51, 12
    s_cmp_le_u32 s51, 436
    s_waitcnt lgkmcnt(4)
    v_mfma_f32_16x16x32_bf16 v[240:243], v[232:235], v[192:195], v[240:243]
    s_waitcnt lgkmcnt(2)
    v_mfma_f32_16x16x32_bf16 v[244:247], v[232:235], v[196:199], v[244:247]
    s_waitcnt lgkmcnt(0)
    v_mfma_f32_16x16x32_bf16 v[248:251], v[232:235], v[200:203], v[248:251]
    s_cbranch_scc1 Ldn_93
    s_nop 2
    v_cndmask_b32 v232, v240, v241, s[4:5]
    v_cndmask_b32 v233, v242, v243, s[4:5]
    v_cndmask_b32 v232, v232, v233, s[6:7]
    buffer_store_dword v232, v29, s[40:43], s44 offen sc1
    v_cndmask_b32 v234, v244, v245, s[4:5]
    v_cndmask_b32 v235, v246, v247, s[4:5]
    v_cndmask_b32 v234, v234, v235, s[6:7]
    buffer_store_dword v234, v29, s[40:43], s44 offen offset:256 sc1
    v_cndmask_b32 v236, v248, v249, s[4:5]
    v_cndmask_b32 v237, v250, v251, s[4:5]
    v_cndmask_b32 v236, v236, v237, s[6:7]
    buffer_store_dword v236, v29, s[40:43], s44 offen offset:512 sc1
    s_branch L_cs_end
L_cs_red:
    s_lshl_b32 s44, s30, 3
    s_add_u32 s44, s44, s31
    s_lshl_b32 s45, s36, 6
    s_add_u32 s44, s44, s45
    s_cmp_ge_u32 s44, 72
    s_cbranch_scc1 L_cs_end
    s_lshr_b32 s54, s44, 1
    s_lshl_b32 s54, s54, 5
    s_and_b32 s45, s44, 1
    s_mul_i32 s45, s45, 2304
    s_add_u32 s54, s54, s45
    v_and_b32 v17, 7, v0
    v_bfe_u32 v42, v0, 2, 1
    v_mul_u32_u24 v42, 1152, v42
    v_lshl_add_u32 v42, v11, 3, v42
    buffer_load_dwordx2 v[40:41], v42, s[60:63], s54 offen
    v_bfe_u32 v16, v0, 3, 2
    v_lshrrev_b32 v18, 5, v0
    v_lshl_add_u32 v16, v18, 4, v16
    v_mul_u32_u24 v16, 9216, v16
    v_lshl_add_u32 v16, v17, 4, v16
    s_lshl_b32 s44, s44, 7
    s_add_u32 s44, s44, 385024
    s_add_u32 s45, s44, 36864
    s_add_u32 s46, s45, 36864
    s_add_u32 s47, s46, 36864
    s_mov_b32 s57, 0xbfb8aa3b
    s_mov_b32 s60, s22
    s_mov_b32 s61, s23
    s_mov_b32 s59, 65536
    s_mov_b32 exec_lo, 1
    s_mov_b32 exec_hi, 1
Lpr_96:
    buffer_load_dword v48, v16, s[40:43], s44 offen sc1
    buffer_load_dword v56, v16, s[40:43], s46 offen sc1
    s_waitcnt vmcnt(0)
    v_min_u32 v64, v48, v56
    v_cmp_ne_u32 vcc, -1, v64
    s_cbranch_vccnz Lprd_97
    s_sleep 4
    s_sub_u32 s59, s59, 1
    s_cmp_lg_u32 s59, 0
    s_cbranch_scc1 Lpr_96
Lprd_97:
    s_mov_b64 exec, -1
    v_lshlrev_b32 v76, 16, v40
    v_and_b32 v77, s56, v40
    v_lshlrev_b32 v78, 16, v41
    v_and_b32 v79, s56, v41
    s_mov_b32 s59, 65536
    s_mov_b64 s[90:91], exec
    buffer_load_dwordx4 v[48:51], v16, s[40:43], s44 offen sc1
    buffer_load_dwordx4 v[52:55], v16, s[40:43], s45 offen sc1
    buffer_load_dwordx4 v[56:59], v16, s[40:43], s46 offen sc1
    buffer_load_dwordx4 v[60:63], v16, s[40:43], s47 offen sc1
    s_sleep 2
    buffer_load_dwordx4 v[48:51], v16, s[40:43], s44 offen sc1
    buffer_load_dwordx4 v[52:55], v16, s[40:43], s45 offen sc1
    buffer_load_dwordx4 v[56:59], v16, s[40:43], s46 offen sc1
    buffer_load_dwordx4 v[60:63], v16, s[40:43], s47 offen sc1
    s_sleep 2
Lgq_98:
    buffer_load_dwordx4 v[48:51], v16, s[40:43], s44 offen sc1
    buffer_load_dwordx4 v[52:55], v16, s[40:43], s45 offen sc1
    buffer_load_dwordx4 v[56:59], v16, s[40:43], s46 offen sc1
    buffer_load_dwordx4 v[60:63], v16, s[40:43], s47 offen sc1
    s_mov_b64 exec, s[90:91]
    s_waitcnt vmcnt(8)
    v_max3_u32 v64, v48, v49, v50
    v_max3_u32 v65, v51, v52, v53
    v_max3_u32 v64, v64, v54, v55
    v_max3_u32 v65, v65, v56, v57
    v_max3_u32 v64, v64, v58, v59
    v_max3_u32 v65, v65, v60, v61
    v_max3_u32 v64, v64, v62, v63
    v_max_u32 v64, v64, v65
    v_cmp_eq_u32 vcc, -1, v64
    s_cbranch_vccz Lgqd_99
    s_mov_b64 exec, vcc
    s_sub_u32 s59, s59, 1
    s_cmp_lg_u32 s59, 0
    s_cbranch_scc1 Lgq_98
    s_mov_b64 exec, s[90:91]
Lgqd_99:
    v_add_f32 v64, v48, v52
    v_add_f32 v65, v49, v53
    v_add_f32 v66, v50, v54
    v_add_f32 v67, v51, v55
    v_add_f32 v68, v56, v60
    v_add_f32 v69, v57, v61
    v_add_f32 v70, v58, v62
    v_add_f32 v71, v59, v63
    v_add_f32 v64, v64, v68
    v_add_f32 v65, v65, v69
    v_add_f32 v66, v66, v70
    v_add_f32 v67, v67, v71
    v_add_f32_dpp v64, v64, v64 row_ror:8 row_mask:0xf bank_mask:0xf
    v_add_f32_dpp v65, v65, v65 row_ror:8 row_mask:0xf bank_mask:0xf
    v_add_f32_dpp v66, v66, v66 row_ror:8 row_mask:0xf bank_mask:0xf
    v_add_f32_dpp v67, v67, v67 row_ror:8 row_mask:0xf bank_mask:0xf
    v_mov_b32 v68, v64
    v_mov_b32 v69, v65
    v_mov_b32 v70, v66
    v_mov_b32 v71, v67
    s_nop 0
    v_permlane16_swap_b32 v64, v68
    v_permlane16_swap_b32 v65, v69
    v_permlane16_swap_b32 v66, v70
    v_permlane16_swap_b32 v67, v71
    v_add_f32 v64, v64, v68
    v_add_f32 v65, v65, v69
    v_add_f32 v66, v66, v70
    v_add_f32 v67, v67, v71
    v_cvt_pk_bf16_f32 v68, v64, v65
    v_cvt_pk_bf16_f32 v69, v66, v67
    v_lshlrev_b32 v64, 16, v68
    v_and_b32 v65, s56, v68
    v_lshlrev_b32 v66, 16, v69
    v_and_b32 v67, s56, v69
    v_mul_f32 v72, s57, v64
    v_mul_f32 v73, s57, v65
    v_mul_f32 v74, s57, v66
    v_mul_f32 v75, s57, v67
    v_exp_f32 v72, v72
    v_exp_f32 v73, v73
    v_exp_f32 v74, v74
    v_exp_f32 v75, v75
    v_add_f32 v72, 1.0, v72
    v_add_f32 v73, 1.0, v73
    v_add_f32 v74, 1.0, v74
    v_add_f32 v75, 1.0, v75
    v_rcp_f32 v72, v72
    v_rcp_f32 v73, v73
    v_rcp_f32 v74, v74
    v_rcp_f32 v75, v75
    v_mul_f32 v72, v72, v64
    v_mul_f32 v73, v73, v65
    v_mul_f32 v74, v74, v66
    v_mul_f32 v75, v75, v67
    v_cvt_pk_bf16_f32 v68, v72, v73
    v_cvt_pk_bf16_f32 v69, v74, v75
    s_nop 1
    v_permlane32_swap_b32 v68, v70
    v_permlane32_swap_b32 v69, v71
    s_nop 0
    v_lshlrev_b32 v72, 16, v70
    v_and_b32 v73, s56, v70
    v_lshlrev_b32 v74, 16, v71
    v_and_b32 v75, s56, v71
    v_mul_f32 v64, v64, v72
    v_mul_f32 v65, v65, v73
    v_mul_f32 v66, v66, v74
    v_mul_f32 v67, v67, v75
    v_cvt_pk_bf16_f32 v68, v64, v65
    v_cvt_pk_bf16_f32 v69, v66, v67
    v_lshlrev_b32 v64, 16, v68
    v_and_b32 v65, s56, v68
    v_lshlrev_b32 v66, 16, v69
    v_and_b32 v67, s56, v69
    v_add_f32 v64, v64, v76
    v_add_f32 v65, v65, v77
    v_add_f32 v66, v66, v78
    v_add_f32 v67, v67, v79
    v_cvt_pk_bf16_f32 v68, v64, v65
    v_cvt_pk_bf16_f32 v69, v66, v67
    s_mov_b64 exec, 0xff
    buffer_store_dwordx2 v[68:69], v42, s[60:63], s54 offen
L_cs_end:
L_end:
    s_endpgm
L_code_end:
.section .rodata,"a"
.p2align 6
.amdhsa_kernel recurrent_scan__sliding_block_cached__geglu_ffn__decode_kernel
  .amdhsa_next_free_vgpr 256
  .amdhsa_next_free_sgpr 102
  .amdhsa_accum_offset 256
  .amdhsa_group_segment_fixed_size 0
  .amdhsa_kernarg_size 96
  .amdhsa_user_sgpr_count 2
  .amdhsa_user_sgpr_kernarg_segment_ptr 1
  .amdhsa_system_sgpr_workgroup_id_x 1
  .amdhsa_float_denorm_mode_32 3
.end_amdhsa_kernel
```
